```python
import torch

def _softmax(x, axis=-1):
    return torch.softmax(x, dim=axis)
def _gelu(x):
    return torch.nn.functional.gelu(x, approximate="tanh")
def _silu(x):
    return torch.nn.functional.silu(x)
def _sigmoid(x):
    return torch.sigmoid(x)
def _layernorm(x, axis=-1, eps=1e-5):
    m = x.mean(dim=axis, keepdim=True)
    v = x.var(dim=axis, keepdim=True, unbiased=False)
    return (x - m) / torch.sqrt(v + eps)
def _scatter_add(tgt, idx, src, axis=0):
    return tgt.clone().index_add_(axis, idx, src)
def _segment_sum(src, seg, n):
    out = torch.zeros((n,) + src.shape[1:], dtype=src.dtype)
    return out.index_add_(0, seg, src)
def _pad(x, pw):
    flat = tuple(v for pair in reversed(pw) for v in pair)
    return torch.nn.functional.pad(x, flat)

kernel_name = 'recurrent_scan__linear_kernel_hedgehog__dense_activation_silu__prompt'

def setup_inputs():

    _w = (lambda a: (lambda t: t.to(torch.bfloat16) if t.is_floating_point() else t)(torch.as_tensor(a)))
    def _A_setup():
        B, S, D, H = 1, 2048, 448, 16
        Dh = D // H
        return {
            "x": _w((lambda *s: torch.randn(*s, dtype=torch.bfloat16) * 0.05)(B, S, D)),
            "wqkv": _w((lambda *s: torch.randn(*s, dtype=torch.bfloat16) * 0.4)(D, 3 * D)),
            "w_phi": _w((lambda *s: torch.randn(*s, dtype=torch.bfloat16) * 0.4)(H, Dh, Dh) * (Dh ** -0.5)),
            "wo": _w((lambda *s: torch.randn(*s, dtype=torch.bfloat16) * 0.2)(D, D)),
        }
    _A_in = _A_setup()

    def _B_setup():
        B, S, D, F = 1, 2048, 448, 1792
        return {
            "x": _w((lambda *s: torch.randn(*s, dtype=torch.bfloat16) * 0.05)(B, S, D)),
            "w1": _w((lambda *s: torch.randn(*s, dtype=torch.bfloat16) * 0.4)(D, F) * (D ** -0.5)),
            "w2": _w((lambda *s: torch.randn(*s, dtype=torch.bfloat16) * 0.1)(F, D) * (F ** -0.5)),
        }
    _B_in = _B_setup()

    return {
        "A_x": _A_in["x"],
        "A_wqkv": _A_in["wqkv"],
        "A_w_phi": _A_in["w_phi"],
        "A_wo": _A_in["wo"],
        "B_x": _B_in["x"],
        "B_w1": _B_in["w1"],
        "B_w2": _B_in["w2"],
    }

def reference(A_x, A_wqkv, A_w_phi, A_wo, B_x, B_w1, B_w2):
    def _A_ref(x, wqkv, w_phi, wo):
        B, S, D = x.shape
        H = 16; Dh = D // H
        qkv = (lambda x, *d: x.permute(*d))((x @ wqkv).reshape(B, S, 3, H, Dh), 2, 0, 3, 1, 4)
        q, k, v = qkv[0], qkv[1], qkv[2]
        pq = torch.einsum("bhsd,hdf->bhsf", q, w_phi)
        pk = torch.einsum("bhsd,hdf->bhsf", k, w_phi)
        phi_q = torch.concatenate([_softmax(pq, axis=-1), _softmax(-pq, axis=-1)], axis=-1)
        phi_k = torch.concatenate([_softmax(pk, axis=-1), _softmax(-pk, axis=-1)], axis=-1)
        kv = torch.einsum("bhsf,bhsd->bhfd", phi_k, v)
        z  = torch.einsum("bhsf->bhf", phi_k)
        num = torch.einsum("bhqf,bhfd->bhqd", phi_q, kv)
        den = torch.einsum("bhqf,bhf->bhq", phi_q, z)[..., None] + 1e-6
        o = num / den
        return (lambda x, *d: x.permute(*d))(o, 0, 2, 1, 3).reshape(B, S, D) @ wo

    def _B_ref(x, w1, w2):
        h = torch.einsum("bsd,df->bsf", x, w1)
        h = _silu(h)
        out = torch.einsum("bsf,fd->bsd", h, w2)
        return out

    x = A_x
    xn = _layernorm(x, axis=-1)
    s = _A_ref(xn, A_wqkv, A_w_phi, A_wo)
    g = _silu(_B_ref(xn, B_w1, B_w2))
    return x + s * g
```

```asm
; @launch grid=(256,1,1) block=(512,1,1) lds=163840
.amdgcn_target "amdgcn-amd-amdhsa--gfx950"
.text
.globl recurrent_scan__linear_kernel_hedgehog__dense_activation_silu__prompt_kernel
.p2align 8
.type recurrent_scan__linear_kernel_hedgehog__dense_activation_silu__prompt_kernel,@function
recurrent_scan__linear_kernel_hedgehog__dense_activation_silu__prompt_kernel:
    s_cmp_ge_u32 s2, 256
    s_cbranch_scc1 L_end
    s_load_dwordx16 s[16:31], s[0:1], 0
    s_load_dwordx4 s[32:35], s[0:1], 64
    s_getpc_b64 s[8:9]
L_pc:
    v_cmp_le_u32 vcc, 448, v0
    s_cbranch_vccz L_nopf
    s_bfe_u32 s10, s2, 0x30003
    s_lshl_b32 s10, s10, 13
    v_and_b32 v1, 63, v0
    v_lshlrev_b32 v1, 7, v1
    v_add_u32 v1, s10, v1
    v_min_u32 v1, L_end-L_pc, v1
    global_load_dword a80, v1, s[8:9]
L_nopf:
    v_lshrrev_b32 v1, 6, v0
    v_and_b32 v0, 63, v0
    v_readfirstlane_b32 s4, v1
    v_mov_b32 v140, v0
    v_lshlrev_b32 v141, 4, v0
    s_and_b32 s8, s2, 7
    s_lshr_b32 s9, s2, 3
    s_and_b32 s10, s8, 1
    s_lshl_b32 s10, s10, 3
    s_and_b32 s11, s9, 7
    s_add_u32 s6, s10, s11
    s_lshr_b32 s8, s8, 1
    s_lshr_b32 s10, s9, 3
    s_lshl_b32 s11, s8, 2
    s_add_u32 s12, s11, s10
    s_mov_b32 s7, 0
    s_lshl_b32 s5, s8, 1
    s_add_u32 s5, s5, s10
    s_cmp_lt_u32 s10, 2
    s_cbranch_scc1 L_role
    s_mov_b32 s7, 1
    s_lshr_b32 s5, 0x4210, s11
    s_and_b32 s5, s5, 15
    s_cmp_eq_u32 s10, 2
    s_cbranch_scc1 L_role
    s_and_b32 s13, s8, 1
    s_lshl_b32 s5, s13, 1
    s_add_u32 s5, s5, 3
    s_bfe_u32 s11, s9, 0x10002
    s_lshr_b32 s8, s8, 1
    s_cmp_lg_u32 s11, s8
    s_cbranch_scc1 L_role
    s_mov_b32 s7, 2
    s_mov_b32 s5, s13
L_role:
    s_lshl_b32 s8, s6, 4
    s_add_u32 s8, s8, s12
    s_lshl_b32 s8, s8, 3
    s_add_u32 s11, s8, s4
    s_mov_b32 s14, -1
    s_mov_b32 s15, 0x00ffffff
    s_and_b32 s68, s4, 3
    s_lshr_b32 s69, s4, 2
    s_mov_b32 s3, 0xffff0000
    v_lshrrev_b32 v2, 3, v0
    v_mul_u32_u24 v2, 896, v2
    v_lshrrev_b32 v3, 4, v0
    v_and_b32 v4, 7, v0
    v_xor_b32 v4, v4, v3
    v_lshl_add_u32 v122, v4, 4, v2
    v_xor_b32 v4, 4, v4
    v_lshl_add_u32 v123, v4, 4, v2
    v_add_u32 v123, 6144, v123
    s_lshl_b32 s8, s6, 3
    s_add_u32 s8, s8, s4
    s_mul_i32 s12, s8, 14336
    v_cmp_lt_u32 vcc, 27, v0
    v_subrev_u32 v7, 28, v0
    s_nop 0
    v_cndmask_b32 v7, v0, v7, vcc
    v_cndmask_b32 v6, 0, 1, vcc
    v_cmp_gt_u32 vcc, 56, v0
    v_mov_b32 v5, 0x7fffffff
    s_nop 0
    v_cndmask_b32 v5, v5, v141, vcc
    s_waitcnt lgkmcnt(0)
    s_mov_b32 s36, s16
    s_and_b32 s37, s17, 0xffff
    s_mov_b32 s38, 1835008
    s_mov_b32 s39, 0x20000
    s_mov_b32 s64, s34
    s_and_b32 s65, s35, 0xffff
    s_mov_b32 s66, 16777216
    s_mov_b32 s67, 0x20000
    s_mov_b32 s60, s32
    s_and_b32 s61, s33, 0xffff
    s_mov_b32 s62, 256
    s_mov_b32 s63, 0x20000
    s_mov_b32 s34, s11
    s_lshl_b32 s33, s4, 11
    s_mul_i32 s32, s4, 3584
    s_add_u32 s32, s32, 16384
    s_cmp_eq_u32 s7, 0
    s_cbranch_scc1 L_ffn
    s_cmp_eq_u32 s7, 2
    s_cbranch_scc1 L_q
L_kv:
    s_mov_b32 s40, s18
    s_and_b32 s41, s19, 0xffff
    s_mov_b32 s42, 1204224
    s_mov_b32 s43, 0x20000
    s_lshl_b32 s8, s5, 2
    s_lshr_b32 s9, 0xdb9630, s8
    s_and_b32 s9, s9, 15
    s_lshr_b32 s10, 0x322333, s8
    s_and_b32 s10, s10, 15
    s_mul_i32 s11, s9, 56
    s_and_b32 s13, s11, -16
    s_and_b32 s11, s11, 8
    s_mul_i32 s8, s10, 3
    s_add_u32 s8, s8, 1
    v_cmp_lt_u32 vcc, 13, v7
    v_subrev_u32 v8, 14, v7
    s_nop 0
    v_cndmask_b32 v8, v7, v8, vcc
    v_min_u32 v8, s8, v8
    v_mov_b32 v9, 896
    v_mov_b32 v10, 1792
    v_cndmask_b32 v9, v9, v10, vcc
    v_mul_u32_u24 v6, 2688, v6
    v_add_u32 v6, v6, v9
    v_lshl_add_u32 v124, v8, 4, v6
    s_mov_b32 s0, s9
    s_mov_b32 s1, s10
    s_mov_b32 s35, s11
    v_add_u32 v125, 4480, v124
    v_add_u32 v126, 8960, v124
    v_add_u32 v127, 13440, v124
    s_mul_i32 s8, s4, 21504
    s_add_u32 s13, s13, s8
    s_add_u32 m0, s32, 0
    s_mov_b64 exec, s[14:15]
    buffer_load_dwordx4 v124, s[40:43], s13 offen offset:0 lds
    buffer_load_dwordx4 v125, s[40:43], s13 offen offset:896 lds
    s_mov_b64 exec, -1
    s_mov_b64 exec, s[14:15]
    buffer_load_dwordx4 v126, s[40:43], s13 offen offset:1792 lds
    buffer_load_dwordx4 v127, s[40:43], s13 offen offset:2688 lds
    s_mov_b64 exec, -1
    s_add_u32 m0, s33, 0
    s_add_u32 s13, s13, 172032
    buffer_load_dwordx4 v122, s[36:39], s12 offen offset:0 lds
    buffer_load_dwordx4 v123, s[36:39], s12 offen offset:1024 lds
    s_add_u32 s12, s12, 128
    s_mul_i32 s8, s34, 896
    buffer_load_dwordx4 v[96:99], v5, s[36:39], s8 offen
    s_or_b32 s8, s2, s4
    s_cmp_lg_u32 s8, 0
    s_cbranch_scc1 L_nononk
    s_memrealtime s[8:9]
    s_waitcnt lgkmcnt(0)
    s_or_b32 s8, s8, 1
    v_mov_b32 v8, s8
    v_mov_b32 v9, 0
    s_mov_b64 exec, 1
    buffer_store_dword v8, v9, s[60:63], 0 offen sc1
    s_mov_b64 exec, -1
L_nononk:
    s_mul_i32 s10, s69, 224
    s_add_u32 s10, s10, s35
    s_add_u32 s10, s10, 16384
    v_and_b32 v128, 31, v0
    v_lshlrev_b32 v128, 7, v128
    s_lshl_b32 s8, s68, 12
    v_add_u32 v128, s8, v128
    v_lshrrev_b32 v129, 5, v0
    v_bfe_u32 v130, v0, 1, 3
    v_xor_b32 v130, v130, v129
    v_lshlrev_b32 v131, 3, v129
    v_bfe_u32 v132, v0, 2, 2
    v_add_u32 v131, v131, v132
    v_mul_u32_u24 v131, 448, v131
    v_bfe_u32 v132, v0, 4, 1
    v_and_b32 v133, 3, v0
    v_lshl_add_u32 v132, v132, 2, v133
    v_min_u32 v132, 6, v132
    v_lshl_add_u32 v131, v132, 3, v131
    v_add_u32 v131, s10, v131
    s_add_u32 s8, s68, s69
    s_add_u32 s8, s8, 0
    s_and_b32 s8, s8, 3
    s_lshl_b32 s9, s8, 1
    v_xor_b32 v133, s9, v130
    v_lshl_add_u32 v112, v133, 4, v128
    s_mul_i32 s9, s8, 7168
    v_add_u32 v116, s9, v131
    s_add_u32 s8, s68, s69
    s_add_u32 s8, s8, 1
    s_and_b32 s8, s8, 3
    s_lshl_b32 s9, s8, 1
    v_xor_b32 v133, s9, v130
    v_lshl_add_u32 v113, v133, 4, v128
    s_mul_i32 s9, s8, 7168
    v_add_u32 v117, s9, v131
    s_add_u32 s8, s68, s69
    s_add_u32 s8, s8, 2
    s_and_b32 s8, s8, 3
    s_lshl_b32 s9, s8, 1
    v_xor_b32 v133, s9, v130
    v_lshl_add_u32 v114, v133, 4, v128
    s_mul_i32 s9, s8, 7168
    v_add_u32 v118, s9, v131
    s_add_u32 s8, s68, s69
    s_add_u32 s8, s8, 3
    s_and_b32 s8, s8, 3
    s_lshl_b32 s9, s8, 1
    v_xor_b32 v133, s9, v130
    v_lshl_add_u32 v115, v133, 4, v128
    s_mul_i32 s9, s8, 7168
    v_add_u32 v119, s9, v131
    s_mov_b32 s44, s20
    s_and_b32 s45, s21, 0xffff
    s_mov_b32 s46, 25088
    s_mov_b32 s47, 0x20000
    s_mov_b32 s48, s22
    s_and_b32 s49, s23, 0xffff
    s_mov_b32 s50, 401408
    s_mov_b32 s51, 0x20000
    s_mov_b32 s52, s28
    s_and_b32 s53, s29, 0xffff
    s_mov_b32 s54, 1605632
    s_mov_b32 s55, 0x20000
    s_mov_b32 s56, s30
    s_and_b32 s57, s31, 0xffff
    s_mov_b32 s58, 1835008
    s_mov_b32 s59, 0x20000
    s_mov_b32 s26, 0x3fb8aa3b
    s_mov_b32 s27, 0x3fb8aa3b
    s_mov_b32 s28, 0
    s_mov_b32 s29, -1
    s_mov_b32 s31, 0
    s_lshr_b32 s9, s2, 3
    s_and_b32 s8, s9, 3
    s_add_u32 s8, s8, 24
    s_cmp_lt_u32 s9, 24
    s_cselect_b32 s9, s9, s8
    s_mul_i32 s8, s9, 37
    s_lshr_b32 s8, s8, 8
    s_mul_i32 s10, s8, 7
    s_sub_u32 s17, s9, s10
    s_and_b32 s10, s2, 7
    s_lshl_b32 s10, s10, 2
    s_add_u32 s16, s10, s8
    s_mul_i32 s18, s4, 200704
    s_lshl_b32 s8, s17, 7
    s_add_u32 s18, s18, s8
    s_lshl_b32 s19, s4, 12
    s_add_u32 s19, s19, 57344
    v_lshrrev_b32 v64, 3, v140
    v_mul_u32_u24 v64, 896, v64
    v_lshrrev_b32 v65, 2, v140
    v_and_b32 v65, 4, v65
    v_and_b32 v66, 7, v140
    v_xor_b32 v65, v65, v66
    v_lshl_add_u32 v139, v65, 4, v64
    v_lshrrev_b32 v64, 5, v140
    v_lshlrev_b32 v64, 2, v64
    v_bfe_u32 v65, v140, 2, 2
    v_add_u32 v64, v64, v65
    v_lshlrev_b32 v64, 7, v64
    v_add_u32 v64, s19, v64
    v_and_b32 v65, 3, v140
    v_lshlrev_b32 v65, 3, v65
    v_and_b32 v66, 16, v140
    v_lshl_add_u32 v65, v66, 1, v65
    v_and_b32 v66, 8, v140
    v_lshlrev_b32 v66, 3, v66
    v_xor_b32 v65, v65, v66
    v_add_u32 v142, v64, v65
    v_xor_b32 v65, 64, v65
    v_add_u32 v143, v64, v65
    s_lshl_b32 s8, s16, 1
    s_mul_i32 s20, s8, 112
    s_mul_i32 s9, s4, 14
    s_add_u32 s20, s20, s9
    s_lshl_b32 s20, s20, 10
    s_add_u32 s21, s20, 114688
    s_bfe_u32 s9, s4, 0x10001
    s_add_u32 s10, s8, s9
    s_mul_i32 s22, s10, 28
    s_mul_i32 s9, s69, 14
    s_add_u32 s22, s22, s9
    s_lshl_b32 s10, s10, 1
    s_add_u32 s10, s10, s69
    s_lshl_b32 s10, s10, 8
    s_add_u32 s99, s10, 11829248
    s_lshl_b32 s22, s22, 10
    s_add_u32 s22, s22, 8388608
    v_lshrrev_b32 v64, 3, v140
    v_mul_u32_u24 v64, 896, v64
    v_and_b32 v65, 7, v140
    v_lshl_add_u32 v64, v65, 4, v64
    v_and_b32 v65, 1, v65
    v_lshlrev_b32 v65, 7, v65
    v_accvgpr_write_b32 a73, v64
    v_accvgpr_write_b32 a74, v65
    s_lshl_b32 s9, s16, 3
    s_add_u32 s9, s9, s4
    s_mul_i32 s9, s9, 7168
    s_lshl_b32 s8, s17, 7
    s_add_u32 s100, s9, s8
    s_lshl_b32 s8, s16, 12
    s_lshl_b32 s9, s4, 8
    s_add_u32 s9, s9, s8
    s_add_u32 s98, s9, 11534336
    v_and_b32 v64, 1, v140
    v_lshlrev_b32 v64, 11, v64
    v_and_b32 v65, 2, v140
    v_lshl_add_u32 v64, v65, 6, v64
    v_accvgpr_write_b32 a72, v64
    v_lshrrev_b32 v66, 5, v140
    v_bfe_u32 v64, v140, 3, 1
    v_xor_b32 v64, v64, v66
    v_mul_u32_u24 v65, 14, v66
    v_bfe_u32 v66, v140, 2, 2
    v_add_u32 v65, v65, v66
    v_lshlrev_b32 v65, 7, v65
    v_lshl_add_u32 v64, v64, 6, v65
    v_and_b32 v65, 3, v140
    v_lshl_add_u32 v64, v65, 3, v64
    v_and_b32 v65, 16, v140
    v_lshl_add_u32 v64, v65, 1, v64
    s_and_b32 s9, s4, 1
    s_lshl_b32 s9, s9, 6
    v_xor_b32 v64, s9, v64
    s_mul_i32 s9, s69, 28672
    v_add_u32 v64, s9, v64
    v_xor_b32 v65, 64, v64
    v_accvgpr_write_b32 a75, v64
    v_accvgpr_write_b32 a76, v65
    v_add_u32 v65, 1792, v65
    v_and_b32 v66, 8, v140
    v_cmp_eq_u32 vcc, 0, v66
    s_nop 1
    v_cndmask_b32 v65, v65, v64, vcc
    v_accvgpr_write_b32 a77, v65
    s_mov_b32 s24, s0
    s_mov_b32 s23, s1
    v_and_b32 v64, 31, v140
    v_mov_b32 v66, 0x7f000000
    v_subrev_u32 v65, 4, v64
    v_cmp_lt_u32 vcc, 27, v64
    s_nop 1
    v_cndmask_b32 v64, v64, v65, vcc
    v_lshlrev_b32 v64, 4, v64
    v_cndmask_b32 v108, v64, v66, s[28:29]
    v_and_b32 v64, 31, v140
    v_lshlrev_b32 v110, 7, v64
    s_mul_i32 s8, s24, 28
    s_mul_i32 s9, s69, 448
    s_add_u32 s8, s8, s9
    s_add_u32 s8, s8, 2240
    s_lshl_b32 s8, s8, 4
    s_add_u32 s30, s8, 12058624
    s_mov_b32 s101, s24
    s_lshl_b32 s8, s24, 13
    s_lshl_b32 s9, s4, 10
    s_add_u32 s8, s8, s9
    s_add_u32 s96, s8, 10485760
    s_add_u32 s97, s96, 16384
    s_cmp_eq_u32 s23, 3
    s_cselect_b32 s97, s97, 0x7f000000
    v_mov_b32 v68, 0
    v_mov_b32 v69, 0
    v_mov_b32 v70, 0
    v_mov_b32 v71, 0
    v_and_b32 v64, 31, v140
    v_lshlrev_b32 v64, 6, v64
    s_lshl_b32 s8, s68, 11
    v_add_u32 v64, s8, v64
    v_bfe_u32 v65, v140, 1, 2
    v_lshl_add_u32 v64, v65, 4, v64
    v_lshrrev_b32 v65, 5, v140
    v_lshl_add_u32 v48, v65, 13, v64
    s_lshl_b32 s9, s69, 5
    v_xor_b32 v48, s9, v48
    v_xor_b32 v49, 16, v48
    s_add_u32 s8, s8, 136192
    v_add_u32 v50, s8, v141
    v_lshl_add_u32 v54, v65, 3, v64
    v_add_u32 v54, 136192, v54
    v_xor_b32 v55, 16, v54
    v_xor_b32 v56, 32, v54
    v_xor_b32 v57, 48, v54
    v_lshlrev_b32 v53, 10, v65
    v_and_b32 v64, 31, v140
    v_lshl_add_u32 v53, v64, 2, v53
    v_lshrrev_b32_e64 v64, 5, v140
    v_bfe_u32 v65, v140, 2, 2
    v_lshl_add_u32 v64, v64, 2, v65
    v_bfe_u32 v65, v140, 4, 1
    v_bfe_u32 v66, v140, 1, 1
    v_lshl_add_u32 v65, v65, 1, v66
    v_lshrrev_b32 v66, 1, v64
    v_xor_b32 v65, v65, v66
    v_lshlrev_b32 v64, 6, v64
    v_lshl_add_u32 v64, v65, 4, v64
    v_and_b32 v65, 1, v140
    v_lshl_add_u32 v64, v65, 3, v64
    s_lshl_b32 s10, s4, 13
    v_add_u32 v52, s10, v64
    s_lshr_b32 s9, s4, 1
    s_lshl_b32 s10, s9, 13
    s_add_u32 s10, s10, 136192
    v_add_u32 v51, s10, v64
    s_add_u32 s10, s9, s24
    s_lshl_b32 s10, s10, 13
    s_and_b32 s8, s4, 1
    s_lshl_b32 s8, s8, 7
    s_add_u32 s10, s10, s8
    s_add_u32 s0, s10, 10485760
    s_cmp_lt_u32 s9, s23
    s_cselect_b32 s23, 1, 0
    s_lshl_b32 s8, s5, 4
    s_add_u32 s8, s8, s6
    s_lshl_b32 s8, s8, 7
    s_add_u32 s1, s8, 11894784
    s_lshl_b32 s24, s5, 7
    s_add_u32 s24, s24, 11911168
    v_mov_b32 v58, 0
    s_barrier
    s_add_u32 m0, s32, 45056
    s_mov_b64 exec, s[14:15]
    buffer_load_dwordx4 v124, s[40:43], s13 offen offset:0 lds
    buffer_load_dwordx4 v125, s[40:43], s13 offen offset:896 lds
    s_mov_b64 exec, -1
    s_mov_b64 exec, s[14:15]
    buffer_load_dwordx4 v126, s[40:43], s13 offen offset:1792 lds
    buffer_load_dwordx4 v127, s[40:43], s13 offen offset:2688 lds
    s_mov_b64 exec, -1
    s_add_u32 m0, s33, 45056
    s_add_u32 s13, s13, 172032
    buffer_load_dwordx4 v122, s[36:39], s12 offen offset:0 lds
    buffer_load_dwordx4 v123, s[36:39], s12 offen offset:1024 lds
    s_add_u32 s12, s12, 128
    s_cmp_lg_u32 s6, 0
    s_cbranch_scc1 L_nozero
    buffer_store_dwordx4 v[68:71], v141, s[64:67], s96 offen sc1
    s_add_u32 s96, s96, 8192
    buffer_store_dwordx4 v[68:71], v141, s[64:67], s96 offen sc1
    buffer_store_dwordx4 v[68:71], v141, s[64:67], s97 offen sc1
    s_nop 1
L_nozero:
    s_mov_b32 s8, 0x3f803f80
    s_waitcnt vmcnt(6)
    v_dot2_f32_bf16 v104, v96, s8, 0
    v_dot2_f32_bf16 v105, v96, v96, 0
    v_dot2_f32_bf16 v104, v97, s8, v104
    v_dot2_f32_bf16 v105, v97, v97, v105
    v_dot2_f32_bf16 v104, v98, s8, v104
    v_dot2_f32_bf16 v105, v98, v98, v105
    v_dot2_f32_bf16 v104, v99, s8, v104
    v_dot2_f32_bf16 v105, v99, v99, v105
    s_nop 1
    v_add_f32_dpp v104, v104, v104 row_shr:1 row_mask:0xf bank_mask:0xf bound_ctrl:0
    v_add_f32_dpp v105, v105, v105 row_shr:1 row_mask:0xf bank_mask:0xf bound_ctrl:0
    s_nop 0
    v_add_f32_dpp v104, v104, v104 row_shr:2 row_mask:0xf bank_mask:0xf bound_ctrl:0
    v_add_f32_dpp v105, v105, v105 row_shr:2 row_mask:0xf bank_mask:0xf bound_ctrl:0
    s_nop 0
    v_add_f32_dpp v104, v104, v104 row_shr:4 row_mask:0xf bank_mask:0xf bound_ctrl:0
    v_add_f32_dpp v105, v105, v105 row_shr:4 row_mask:0xf bank_mask:0xf bound_ctrl:0
    s_nop 0
    v_add_f32_dpp v104, v104, v104 row_shr:8 row_mask:0xf bank_mask:0xf bound_ctrl:0
    v_add_f32_dpp v105, v105, v105 row_shr:8 row_mask:0xf bank_mask:0xf bound_ctrl:0
    s_nop 0
    v_add_f32_dpp v104, v104, v104 row_bcast:15 row_mask:0xa bank_mask:0xf
    v_add_f32_dpp v105, v105, v105 row_bcast:15 row_mask:0xa bank_mask:0xf
    s_nop 0
    v_add_f32_dpp v104, v104, v104 row_bcast:31 row_mask:0xc bank_mask:0xf
    v_add_f32_dpp v105, v105, v105 row_bcast:31 row_mask:0xc bank_mask:0xf
    v_mul_f32 v104, 0x3b124925, v104
    v_mul_f32 v105, 0x3b124925, v105
    v_fma_f32 v105, -v104, v104, v105
    v_max_f32 v105, 0, v105
    v_cvt_pk_bf16_f32 v104, v104, v104
    v_lshlrev_b32 v104, 16, v104
    v_cvt_pk_bf16_f32 v105, v105, v105
    v_lshlrev_b32 v105, 16, v105
    v_add_f32 v105, 0x3727c5ac, v105
    v_cvt_pk_bf16_f32 v105, v105, v105
    v_lshlrev_b32 v105, 16, v105
    v_sqrt_f32 v105, v105
    s_nop 0
    v_cvt_pk_bf16_f32 v105, v105, v105
    v_lshlrev_b32 v105, 16, v105
    v_rcp_f32 v105, v105
    v_sub_f32 v104, 0, v104
    s_barrier
    ds_read_b128 v[96:99], v112
    ds_read_b64_tr_b16 v[64:65], v116 offset:0
    ds_read_b64_tr_b16 v[66:67], v116 offset:1792
    ds_read_b64_tr_b16 v[68:69], v116 offset:56
    ds_read_b64_tr_b16 v[70:71], v116 offset:1848
    ds_read_b64_tr_b16 v[72:73], v116 offset:112
    ds_read_b64_tr_b16 v[74:75], v116 offset:1904
    ds_read_b64_tr_b16 v[76:77], v117 offset:56
    ds_read_b64_tr_b16 v[78:79], v117 offset:1848
    s_waitcnt lgkmcnt(4)
    v_mfma_f32_32x32x16_bf16 v[0:15], v[64:67], v[96:99], 0
    ds_read_b64_tr_b16 v[80:81], v117 offset:112
    ds_read_b64_tr_b16 v[82:83], v117 offset:1904
    ds_read_b128 v[100:103], v113
    s_add_u32 m0, s32, 90112
    s_mov_b64 exec, s[14:15]
    buffer_load_dwordx4 v124, s[40:43], s13 offen offset:0 lds
    buffer_load_dwordx4 v125, s[40:43], s13 offen offset:896 lds
    s_mov_b64 exec, -1
    v_mfma_f32_32x32x16_bf16 v[16:31], v[68:71], v[96:99], 0
    ds_read_b64_tr_b16 v[84:85], v117 offset:0
    ds_read_b64_tr_b16 v[86:87], v117 offset:1792
    s_waitcnt lgkmcnt(5)
    v_mfma_f32_32x32x16_bf16 v[32:47], v[72:75], v[96:99], 0
    ds_read_b64_tr_b16 v[88:89], v118 offset:112
    ds_read_b64_tr_b16 v[90:91], v118 offset:1904
    s_waitcnt lgkmcnt(4)
    v_mfma_f32_32x32x16_bf16 v[16:31], v[76:79], v[100:103], v[16:31]
    ds_read_b64_tr_b16 v[92:93], v118 offset:0
    ds_read_b64_tr_b16 v[94:95], v118 offset:1792
    ds_read_b128 v[96:99], v114
    s_mov_b64 exec, s[14:15]
    buffer_load_dwordx4 v126, s[40:43], s13 offen offset:1792 lds
    buffer_load_dwordx4 v127, s[40:43], s13 offen offset:2688 lds
    s_mov_b64 exec, -1
    s_waitcnt lgkmcnt(5)
    v_mfma_f32_32x32x16_bf16 v[32:47], v[80:83], v[100:103], v[32:47]
    ds_read_b64_tr_b16 v[64:65], v118 offset:56
    ds_read_b64_tr_b16 v[66:67], v118 offset:1848
    v_mfma_f32_32x32x16_bf16 v[0:15], v[84:87], v[100:103], v[0:15]
    ds_read_b64_tr_b16 v[68:69], v119 offset:0
    ds_read_b64_tr_b16 v[70:71], v119 offset:1792
    s_waitcnt lgkmcnt(4)
    v_mfma_f32_32x32x16_bf16 v[32:47], v[88:91], v[96:99], v[32:47]
    ds_read_b64_tr_b16 v[72:73], v119 offset:56
    ds_read_b64_tr_b16 v[74:75], v119 offset:1848
    ds_read_b128 v[100:103], v115
    s_add_u32 m0, s33, 90112
    s_add_u32 s13, s13, 172032
    buffer_load_dwordx4 v122, s[36:39], s12 offen offset:0 lds
    buffer_load_dwordx4 v123, s[36:39], s12 offen offset:1024 lds
    s_add_u32 s12, s12, 128
    v_mfma_f32_32x32x16_bf16 v[0:15], v[92:95], v[96:99], v[0:15]
    ds_read_b64_tr_b16 v[76:77], v119 offset:112
    ds_read_b64_tr_b16 v[78:79], v119 offset:1904
    s_waitcnt lgkmcnt(5)
    v_mfma_f32_32x32x16_bf16 v[16:31], v[64:67], v[96:99], v[16:31]
    v_add_u32 v112, 45056, v112
    v_add_u32 v113, 45056, v113
    v_add_u32 v114, 45056, v114
    v_add_u32 v115, 45056, v115
    v_add_u32 v116, 45056, v116
    v_add_u32 v117, 45056, v117
    v_add_u32 v118, 45056, v118
    v_add_u32 v119, 45056, v119
    s_waitcnt lgkmcnt(0)
    s_waitcnt vmcnt(6)
    s_barrier
    ds_read_b64_tr_b16 v[80:81], v116 offset:0
    ds_read_b64_tr_b16 v[82:83], v116 offset:1792
    v_mov_b32 v107, 0
    buffer_load_dword v106, v107, s[60:63], 0 offen sc1
    v_mfma_f32_32x32x16_bf16 v[0:15], v[68:71], v[100:103], v[0:15]
    ds_read_b64_tr_b16 v[84:85], v116 offset:56
    ds_read_b64_tr_b16 v[86:87], v116 offset:1848
    ds_read_b128 v[96:99], v112
    s_add_u32 m0, s32, 0
    s_mov_b64 exec, s[14:15]
    buffer_load_dwordx4 v124, s[40:43], s13 offen offset:0 lds
    buffer_load_dwordx4 v125, s[40:43], s13 offen offset:896 lds
    s_mov_b64 exec, -1
    v_mfma_f32_32x32x16_bf16 v[16:31], v[72:75], v[100:103], v[16:31]
    ds_read_b64_tr_b16 v[88:89], v116 offset:112
    ds_read_b64_tr_b16 v[90:91], v116 offset:1904
    v_mfma_f32_32x32x16_bf16 v[32:47], v[76:79], v[100:103], v[32:47]
    ds_read_b64_tr_b16 v[92:93], v117 offset:56
    ds_read_b64_tr_b16 v[94:95], v117 offset:1848
    s_waitcnt lgkmcnt(4)
    v_mfma_f32_32x32x16_bf16 v[0:15], v[80:83], v[96:99], v[0:15]
    ds_read_b64_tr_b16 v[64:65], v117 offset:112
    ds_read_b64_tr_b16 v[66:67], v117 offset:1904
    ds_read_b128 v[100:103], v113
    s_mov_b64 exec, s[14:15]
    buffer_load_dwordx4 v126, s[40:43], s13 offen offset:1792 lds
    buffer_load_dwordx4 v127, s[40:43], s13 offen offset:2688 lds
    s_mov_b64 exec, -1
    v_mfma_f32_32x32x16_bf16 v[16:31], v[84:87], v[96:99], v[16:31]
    ds_read_b64_tr_b16 v[68:69], v117 offset:0
    ds_read_b64_tr_b16 v[70:71], v117 offset:1792
    s_waitcnt lgkmcnt(5)
    v_mfma_f32_32x32x16_bf16 v[32:47], v[88:91], v[96:99], v[32:47]
    ds_read_b64_tr_b16 v[72:73], v118 offset:112
    ds_read_b64_tr_b16 v[74:75], v118 offset:1904
    s_waitcnt lgkmcnt(4)
    v_mfma_f32_32x32x16_bf16 v[16:31], v[92:95], v[100:103], v[16:31]
    ds_read_b64_tr_b16 v[76:77], v118 offset:0
    ds_read_b64_tr_b16 v[78:79], v118 offset:1792
    ds_read_b128 v[96:99], v114
    s_add_u32 m0, s33, 0
    s_add_u32 s13, s13, 172032
    buffer_load_dwordx4 v122, s[36:39], s12 offen offset:0 lds
    buffer_load_dwordx4 v123, s[36:39], s12 offen offset:1024 lds
    s_add_u32 s12, s12, 128
    s_waitcnt lgkmcnt(5)
    v_mfma_f32_32x32x16_bf16 v[32:47], v[64:67], v[100:103], v[32:47]
    ds_read_b64_tr_b16 v[80:81], v118 offset:56
    ds_read_b64_tr_b16 v[82:83], v118 offset:1848
    v_mfma_f32_32x32x16_bf16 v[0:15], v[68:71], v[100:103], v[0:15]
    ds_read_b64_tr_b16 v[84:85], v119 offset:0
    ds_read_b64_tr_b16 v[86:87], v119 offset:1792
    s_waitcnt lgkmcnt(4)
    v_mfma_f32_32x32x16_bf16 v[32:47], v[72:75], v[96:99], v[32:47]
    ds_read_b64_tr_b16 v[88:89], v119 offset:56
    ds_read_b64_tr_b16 v[90:91], v119 offset:1848
    ds_read_b128 v[100:103], v115
    v_mfma_f32_32x32x16_bf16 v[0:15], v[76:79], v[96:99], v[0:15]
    ds_read_b64_tr_b16 v[92:93], v119 offset:112
    ds_read_b64_tr_b16 v[94:95], v119 offset:1904
    s_waitcnt lgkmcnt(5)
    v_mfma_f32_32x32x16_bf16 v[16:31], v[80:83], v[96:99], v[16:31]
    v_add_u32 v112, 45056, v112
    v_add_u32 v113, 45056, v113
    v_add_u32 v114, 45056, v114
    v_add_u32 v115, 45056, v115
    v_add_u32 v116, 45056, v116
    v_add_u32 v117, 45056, v117
    v_add_u32 v118, 45056, v118
    v_add_u32 v119, 45056, v119
    s_waitcnt lgkmcnt(0)
    s_waitcnt vmcnt(7)
    s_barrier
    ds_read_b64_tr_b16 v[64:65], v116 offset:0
    ds_read_b64_tr_b16 v[66:67], v116 offset:1792
    s_mul_i32 s8, s101, 1568
    s_lshl_b32 s9, s4, 10
    s_add_u32 s8, s8, s9
    s_add_u32 s9, s9, 144384
    s_add_u32 m0, s9, 0
    s_add_u32 s10, s8, 0
    buffer_load_dwordx4 v141, s[44:47], s10 offen lds
    v_mfma_f32_32x32x16_bf16 v[0:15], v[84:87], v[100:103], v[0:15]
    ds_read_b64_tr_b16 v[68:69], v116 offset:56
    ds_read_b64_tr_b16 v[70:71], v116 offset:1848
    ds_read_b128 v[96:99], v112
    s_add_u32 m0, s32, 45056
    s_mov_b64 exec, s[14:15]
    buffer_load_dwordx4 v124, s[40:43], s13 offen offset:0 lds
    buffer_load_dwordx4 v125, s[40:43], s13 offen offset:896 lds
    s_mov_b64 exec, -1
    v_mfma_f32_32x32x16_bf16 v[16:31], v[88:91], v[100:103], v[16:31]
    ds_read_b64_tr_b16 v[72:73], v116 offset:112
    ds_read_b64_tr_b16 v[74:75], v116 offset:1904
    v_mfma_f32_32x32x16_bf16 v[32:47], v[92:95], v[100:103], v[32:47]
    ds_read_b64_tr_b16 v[76:77], v117 offset:56
    ds_read_b64_tr_b16 v[78:79], v117 offset:1848
    s_waitcnt lgkmcnt(4)
    v_mfma_f32_32x32x16_bf16 v[0:15], v[64:67], v[96:99], v[0:15]
    ds_read_b64_tr_b16 v[80:81], v117 offset:112
    ds_read_b64_tr_b16 v[82:83], v117 offset:1904
    ds_read_b128 v[100:103], v113
    s_mov_b64 exec, s[14:15]
    buffer_load_dwordx4 v126, s[40:43], s13 offen offset:1792 lds
    buffer_load_dwordx4 v127, s[40:43], s13 offen offset:2688 lds
    s_mov_b64 exec, -1
    v_mfma_f32_32x32x16_bf16 v[16:31], v[68:71], v[96:99], v[16:31]
    ds_read_b64_tr_b16 v[84:85], v117 offset:0
    ds_read_b64_tr_b16 v[86:87], v117 offset:1792
    s_waitcnt lgkmcnt(5)
    v_mfma_f32_32x32x16_bf16 v[32:47], v[72:75], v[96:99], v[32:47]
    ds_read_b64_tr_b16 v[88:89], v118 offset:112
    ds_read_b64_tr_b16 v[90:91], v118 offset:1904
    s_waitcnt lgkmcnt(4)
    v_mfma_f32_32x32x16_bf16 v[16:31], v[76:79], v[100:103], v[16:31]
    ds_read_b64_tr_b16 v[92:93], v118 offset:0
    ds_read_b64_tr_b16 v[94:95], v118 offset:1792
    ds_read_b128 v[96:99], v114
    s_add_u32 m0, s33, 45056
    s_add_u32 s13, s13, 172032
    buffer_load_dwordx4 v122, s[36:39], s12 offen offset:0 lds
    buffer_load_dwordx4 v123, s[36:39], s12 offen offset:1024 lds
    s_add_u32 s12, s12, 128
    s_waitcnt lgkmcnt(5)
    v_mfma_f32_32x32x16_bf16 v[32:47], v[80:83], v[100:103], v[32:47]
    ds_read_b64_tr_b16 v[64:65], v118 offset:56
    ds_read_b64_tr_b16 v[66:67], v118 offset:1848
    v_mfma_f32_32x32x16_bf16 v[0:15], v[84:87], v[100:103], v[0:15]
    ds_read_b64_tr_b16 v[68:69], v119 offset:0
    ds_read_b64_tr_b16 v[70:71], v119 offset:1792
    s_waitcnt lgkmcnt(4)
    v_mfma_f32_32x32x16_bf16 v[32:47], v[88:91], v[96:99], v[32:47]
    ds_read_b64_tr_b16 v[72:73], v119 offset:56
    ds_read_b64_tr_b16 v[74:75], v119 offset:1848
    ds_read_b128 v[100:103], v115
    v_mfma_f32_32x32x16_bf16 v[0:15], v[92:95], v[96:99], v[0:15]
    ds_read_b64_tr_b16 v[76:77], v119 offset:112
    ds_read_b64_tr_b16 v[78:79], v119 offset:1904
    s_waitcnt lgkmcnt(5)
    v_mfma_f32_32x32x16_bf16 v[16:31], v[64:67], v[96:99], v[16:31]
    v_subrev_u32 v112, 90112, v112
    v_subrev_u32 v113, 90112, v113
    v_subrev_u32 v114, 90112, v114
    v_subrev_u32 v115, 90112, v115
    v_subrev_u32 v116, 90112, v116
    v_subrev_u32 v117, 90112, v117
    v_subrev_u32 v118, 90112, v118
    v_subrev_u32 v119, 90112, v119
    s_waitcnt vmcnt(13)
    v_readfirstlane_b32 s35, v106
    s_nop 0
    s_cmp_lg_u32 s35, 0
    s_cbranch_scc1 L_gotnk
L_spinnk:
    buffer_load_dword v106, v107, s[60:63], 0 offen sc1
    s_waitcnt vmcnt(0)
    v_readfirstlane_b32 s35, v106
    s_nop 1
    s_cmp_lg_u32 s35, 0
    s_cbranch_scc1 L_gotnk
    s_nop 0
    s_add_u32 s31, s31, 1
    s_cmp_lt_u32 s31, 0x8000
    s_cbranch_scc1 L_spinnk
L_gotnk:
    v_mov_b32 v106, s35
    v_mov_b32 v107, s35
    s_lshl_b32 s8, s34, 4
    s_add_u32 s8, s8, 11927552
    v_mov_b32 v136, 0
    s_mov_b32 exec_lo, 0
    s_mov_b32 exec_hi, 0x80000000
    buffer_store_dwordx4 v[104:107], v136, s[64:67], s8 offen sc1
    s_mov_b64 exec, -1
    s_waitcnt lgkmcnt(0)
    s_waitcnt vmcnt(8)
    s_barrier
    ds_read_b64_tr_b16 v[80:81], v116 offset:0
    ds_read_b64_tr_b16 v[82:83], v116 offset:1792
    s_add_u32 m0, s32, 90112
    s_mov_b64 exec, s[14:15]
    buffer_load_dwordx4 v124, s[40:43], s13 offen offset:0 lds
    buffer_load_dwordx4 v125, s[40:43], s13 offen offset:896 lds
    s_mov_b64 exec, -1
    v_mfma_f32_32x32x16_bf16 v[0:15], v[68:71], v[100:103], v[0:15]
    ds_read_b64_tr_b16 v[84:85], v116 offset:56
    ds_read_b64_tr_b16 v[86:87], v116 offset:1848
    ds_read_b128 v[96:99], v112
    s_mov_b64 exec, s[14:15]
    buffer_load_dwordx4 v126, s[40:43], s13 offen offset:1792 lds
    buffer_load_dwordx4 v127, s[40:43], s13 offen offset:2688 lds
    s_mov_b64 exec, -1
    v_mfma_f32_32x32x16_bf16 v[16:31], v[72:75], v[100:103], v[16:31]
    ds_read_b64_tr_b16 v[88:89], v116 offset:112
    ds_read_b64_tr_b16 v[90:91], v116 offset:1904
    v_mfma_f32_32x32x16_bf16 v[32:47], v[76:79], v[100:103], v[32:47]
    ds_read_b64_tr_b16 v[92:93], v117 offset:56
    ds_read_b64_tr_b16 v[94:95], v117 offset:1848
    s_waitcnt lgkmcnt(4)
    v_mfma_f32_32x32x16_bf16 v[0:15], v[80:83], v[96:99], v[0:15]
    ds_read_b64_tr_b16 v[64:65], v117 offset:112
    ds_read_b64_tr_b16 v[66:67], v117 offset:1904
    ds_read_b128 v[100:103], v113
    s_add_u32 m0, s33, 90112
    s_add_u32 s13, s13, 172032
    buffer_load_dwordx4 v122, s[36:39], s12 offen offset:0 lds
    buffer_load_dwordx4 v123, s[36:39], s12 offen offset:1024 lds
    s_add_u32 s12, s12, 128
    v_mfma_f32_32x32x16_bf16 v[16:31], v[84:87], v[96:99], v[16:31]
    ds_read_b64_tr_b16 v[68:69], v117 offset:0
    ds_read_b64_tr_b16 v[70:71], v117 offset:1792
    s_waitcnt lgkmcnt(5)
    v_mfma_f32_32x32x16_bf16 v[32:47], v[88:91], v[96:99], v[32:47]
    ds_read_b64_tr_b16 v[72:73], v118 offset:112
    ds_read_b64_tr_b16 v[74:75], v118 offset:1904
    s_waitcnt lgkmcnt(4)
    v_mfma_f32_32x32x16_bf16 v[16:31], v[92:95], v[100:103], v[16:31]
    ds_read_b64_tr_b16 v[76:77], v118 offset:0
    ds_read_b64_tr_b16 v[78:79], v118 offset:1792
    ds_read_b128 v[96:99], v114
    s_lshl_b32 s8, s2, 3
    s_add_u32 s8, s8, s4
    s_mul_i32 s9, s8, 896
    s_lshl_b32 s8, s8, 8
    v_lshlrev_b32 v132, 7, v140
    s_mov_b64 exec, 0x7f
    buffer_load_dword a80, v132, s[52:55], s9 offen
    s_mov_b64 exec, 3
    buffer_load_dword a80, v132, s[48:51], s8 offen
    s_mov_b64 exec, -1
    s_waitcnt lgkmcnt(5)
    v_mfma_f32_32x32x16_bf16 v[32:47], v[64:67], v[100:103], v[32:47]
    ds_read_b64_tr_b16 v[80:81], v118 offset:56
    ds_read_b64_tr_b16 v[82:83], v118 offset:1848
    v_mfma_f32_32x32x16_bf16 v[0:15], v[68:71], v[100:103], v[0:15]
    ds_read_b64_tr_b16 v[84:85], v119 offset:0
    ds_read_b64_tr_b16 v[86:87], v119 offset:1792
    s_waitcnt lgkmcnt(4)
    v_mfma_f32_32x32x16_bf16 v[32:47], v[72:75], v[96:99], v[32:47]
    ds_read_b64_tr_b16 v[88:89], v119 offset:56
    ds_read_b64_tr_b16 v[90:91], v119 offset:1848
    ds_read_b128 v[100:103], v115
    s_or_b32 s8, s6, s4
    s_cmp_lg_u32 s8, 0
    s_cbranch_scc1 L_nozf
    s_lshl_b32 s8, s5, 7
    s_add_u32 s8, s8, 11911168
    v_mov_b32 v136, s35
    v_mov_b32 v137, 0
    s_mov_b64 exec, 1
    buffer_store_dword v136, v137, s[64:67], s8 offen sc1
    s_mov_b64 exec, -1
L_nozf:
    v_mfma_f32_32x32x16_bf16 v[0:15], v[76:79], v[96:99], v[0:15]
    ds_read_b64_tr_b16 v[92:93], v119 offset:112
    ds_read_b64_tr_b16 v[94:95], v119 offset:1904
    s_waitcnt lgkmcnt(5)
    v_mfma_f32_32x32x16_bf16 v[16:31], v[80:83], v[96:99], v[16:31]
    v_add_u32 v112, 45056, v112
    v_add_u32 v113, 45056, v113
    v_add_u32 v114, 45056, v114
    v_add_u32 v115, 45056, v115
    v_add_u32 v116, 45056, v116
    v_add_u32 v117, 45056, v117
    v_add_u32 v118, 45056, v118
    v_add_u32 v119, 45056, v119
    s_waitcnt lgkmcnt(0)
    s_waitcnt vmcnt(9)
    s_barrier
    ds_read_b64_tr_b16 v[64:65], v116 offset:0
    ds_read_b64_tr_b16 v[66:67], v116 offset:1792
    s_add_u32 m0, s32, 0
    s_mov_b64 exec, s[14:15]
    buffer_load_dwordx4 v124, s[40:43], s13 offen offset:0 lds
    buffer_load_dwordx4 v125, s[40:43], s13 offen offset:896 lds
    s_mov_b64 exec, -1
    v_mfma_f32_32x32x16_bf16 v[0:15], v[84:87], v[100:103], v[0:15]
    ds_read_b64_tr_b16 v[68:69], v116 offset:56
    ds_read_b64_tr_b16 v[70:71], v116 offset:1848
    ds_read_b128 v[96:99], v112
    s_mov_b64 exec, s[14:15]
    buffer_load_dwordx4 v126, s[40:43], s13 offen offset:1792 lds
    buffer_load_dwordx4 v127, s[40:43], s13 offen offset:2688 lds
    s_mov_b64 exec, -1
    v_mfma_f32_32x32x16_bf16 v[16:31], v[88:91], v[100:103], v[16:31]
    ds_read_b64_tr_b16 v[72:73], v116 offset:112
    ds_read_b64_tr_b16 v[74:75], v116 offset:1904
    v_mfma_f32_32x32x16_bf16 v[32:47], v[92:95], v[100:103], v[32:47]
    ds_read_b64_tr_b16 v[76:77], v117 offset:56
    ds_read_b64_tr_b16 v[78:79], v117 offset:1848
    s_waitcnt lgkmcnt(4)
    v_mfma_f32_32x32x16_bf16 v[0:15], v[64:67], v[96:99], v[0:15]
    ds_read_b64_tr_b16 v[80:81], v117 offset:112
    ds_read_b64_tr_b16 v[82:83], v117 offset:1904
    ds_read_b128 v[100:103], v113
    s_add_u32 m0, s33, 0
    s_add_u32 s13, s13, 172032
    buffer_load_dwordx4 v122, s[36:39], s12 offen offset:0 lds
    buffer_load_dwordx4 v123, s[36:39], s12 offen offset:1024 lds
    s_add_u32 s12, s12, 128
    v_mfma_f32_32x32x16_bf16 v[16:31], v[68:71], v[96:99], v[16:31]
    ds_read_b64_tr_b16 v[84:85], v117 offset:0
    ds_read_b64_tr_b16 v[86:87], v117 offset:1792
    s_waitcnt lgkmcnt(5)
    v_mfma_f32_32x32x16_bf16 v[32:47], v[72:75], v[96:99], v[32:47]
    ds_read_b64_tr_b16 v[88:89], v118 offset:112
    ds_read_b64_tr_b16 v[90:91], v118 offset:1904
    s_waitcnt lgkmcnt(4)
    v_mfma_f32_32x32x16_bf16 v[16:31], v[76:79], v[100:103], v[16:31]
    ds_read_b64_tr_b16 v[92:93], v118 offset:0
    ds_read_b64_tr_b16 v[94:95], v118 offset:1792
    ds_read_b128 v[96:99], v114
    s_mov_b32 s8, 144384
    v_lshrrev_b32 v137, 5, v140
    v_lshlrev_b32 v137, 2, v137
    v_bfe_u32 v138, v140, 2, 2
    v_add_u32 v137, v137, v138
    v_mul_u32_u24 v137, 56, v137
    v_add_u32 v137, s8, v137
    v_bfe_u32 v138, v140, 4, 1
    v_lshlrev_b32 v138, 2, v138
    v_and_or_b32 v138, v140, 3, v138
    v_min_u32 v138, 6, v138
    v_lshl_add_u32 v137, v138, 3, v137
    ds_read_b64_tr_b16 a[88:89], v137 offset:0
    ds_read_b64_tr_b16 a[90:91], v137 offset:448
    ds_read_b64_tr_b16 a[92:93], v137 offset:896
    ds_read_b64_tr_b16 a[94:95], v137 offset:1344
    ds_read_b64_tr_b16 a[96:97], v137 offset:1568
    ds_read_b64_tr_b16 a[98:99], v137 offset:2016
    ds_read_b64_tr_b16 a[100:101], v137 offset:2464
    ds_read_b64_tr_b16 a[102:103], v137 offset:2912
    ds_read_b64_tr_b16 a[104:105], v137 offset:3136
    ds_read_b64_tr_b16 a[106:107], v137 offset:3584
    ds_read_b64_tr_b16 a[108:109], v137 offset:4032
    ds_read_b64_tr_b16 a[110:111], v137 offset:4480
    s_waitcnt lgkmcnt(15)
    v_mfma_f32_32x32x16_bf16 v[32:47], v[80:83], v[100:103], v[32:47]
    ds_read_b64_tr_b16 v[64:65], v118 offset:56
    ds_read_b64_tr_b16 v[66:67], v118 offset:1848
    v_mfma_f32_32x32x16_bf16 v[0:15], v[84:87], v[100:103], v[0:15]
    ds_read_b64_tr_b16 v[68:69], v119 offset:0
    ds_read_b64_tr_b16 v[70:71], v119 offset:1792
    s_waitcnt lgkmcnt(15)
    v_mfma_f32_32x32x16_bf16 v[32:47], v[88:91], v[96:99], v[32:47]
    ds_read_b64_tr_b16 v[72:73], v119 offset:56
    ds_read_b64_tr_b16 v[74:75], v119 offset:1848
    ds_read_b128 v[100:103], v115
    v_mfma_f32_32x32x16_bf16 v[0:15], v[92:95], v[96:99], v[0:15]
    ds_read_b64_tr_b16 v[76:77], v119 offset:112
    ds_read_b64_tr_b16 v[78:79], v119 offset:1904
    s_waitcnt lgkmcnt(5)
    v_mfma_f32_32x32x16_bf16 v[16:31], v[64:67], v[96:99], v[16:31]
    v_add_u32 v112, 45056, v112
    v_add_u32 v113, 45056, v113
    v_add_u32 v114, 45056, v114
    v_add_u32 v115, 45056, v115
    v_add_u32 v116, 45056, v116
    v_add_u32 v117, 45056, v117
    v_add_u32 v118, 45056, v118
    v_add_u32 v119, 45056, v119
    s_waitcnt lgkmcnt(0)
    s_waitcnt vmcnt(8)
    s_barrier
    ds_read_b64_tr_b16 v[80:81], v116 offset:0
    ds_read_b64_tr_b16 v[82:83], v116 offset:1792
    s_mov_b32 s101, 11993088
    buffer_load_dword v111, v110, s[64:67], s101 offen sc1
    v_mfma_f32_32x32x16_bf16 v[0:15], v[68:71], v[100:103], v[0:15]
    ds_read_b64_tr_b16 v[84:85], v116 offset:56
    ds_read_b64_tr_b16 v[86:87], v116 offset:1848
    ds_read_b128 v[96:99], v112
    v_add_u32 v125, 6144, v139
    v_mfma_f32_32x32x16_bf16 v[16:31], v[72:75], v[100:103], v[16:31]
    ds_read_b64_tr_b16 v[88:89], v116 offset:112
    ds_read_b64_tr_b16 v[90:91], v116 offset:1904
    v_mfma_f32_32x32x16_bf16 v[32:47], v[76:79], v[100:103], v[32:47]
    ds_read_b64_tr_b16 v[92:93], v117 offset:56
    ds_read_b64_tr_b16 v[94:95], v117 offset:1848
    s_waitcnt lgkmcnt(4)
    v_mfma_f32_32x32x16_bf16 v[0:15], v[80:83], v[96:99], v[0:15]
    ds_read_b64_tr_b16 v[64:65], v117 offset:112
    ds_read_b64_tr_b16 v[66:67], v117 offset:1904
    ds_read_b128 v[100:103], v113
    s_add_u32 m0, s19, 0
    s_add_u32 s8, s18, 0
    buffer_load_dwordx4 v139, s[52:55], s8 offen lds
    buffer_load_dwordx4 v125, s[52:55], s8 offen offset:1024 lds
    v_mfma_f32_32x32x16_bf16 v[16:31], v[84:87], v[96:99], v[16:31]
    ds_read_b64_tr_b16 v[68:69], v117 offset:0
    ds_read_b64_tr_b16 v[70:71], v117 offset:1792
    s_waitcnt lgkmcnt(5)
    v_mfma_f32_32x32x16_bf16 v[32:47], v[88:91], v[96:99], v[32:47]
    ds_read_b64_tr_b16 v[72:73], v118 offset:112
    ds_read_b64_tr_b16 v[74:75], v118 offset:1904
    s_waitcnt lgkmcnt(4)
    v_mfma_f32_32x32x16_bf16 v[16:31], v[92:95], v[100:103], v[16:31]
    ds_read_b64_tr_b16 v[76:77], v118 offset:0
    ds_read_b64_tr_b16 v[78:79], v118 offset:1792
    ds_read_b128 v[96:99], v114
    s_add_u32 m0, s19, 2048
    s_add_u32 s8, s18, 14336
    buffer_load_dwordx4 v139, s[52:55], s8 offen lds
    buffer_load_dwordx4 v125, s[52:55], s8 offen offset:1024 lds
    s_waitcnt lgkmcnt(5)
    v_mfma_f32_32x32x16_bf16 v[32:47], v[64:67], v[100:103], v[32:47]
    ds_read_b64_tr_b16 v[80:81], v118 offset:56
    ds_read_b64_tr_b16 v[82:83], v118 offset:1848
    v_mfma_f32_32x32x16_bf16 v[0:15], v[68:71], v[100:103], v[0:15]
    ds_read_b64_tr_b16 v[84:85], v119 offset:0
    ds_read_b64_tr_b16 v[86:87], v119 offset:1792
    s_waitcnt lgkmcnt(4)
    v_mfma_f32_32x32x16_bf16 v[32:47], v[72:75], v[96:99], v[32:47]
    ds_read_b64_tr_b16 v[88:89], v119 offset:56
    ds_read_b64_tr_b16 v[90:91], v119 offset:1848
    ds_read_b128 v[100:103], v115
    v_mfma_f32_32x32x16_bf16 v[0:15], v[76:79], v[96:99], v[0:15]
    ds_read_b64_tr_b16 v[92:93], v119 offset:112
    ds_read_b64_tr_b16 v[94:95], v119 offset:1904
    s_waitcnt lgkmcnt(5)
    v_mfma_f32_32x32x16_bf16 v[16:31], v[80:83], v[96:99], v[16:31]
    v_subrev_u32 v112, 90112, v112
    v_subrev_u32 v113, 90112, v113
    v_subrev_u32 v114, 90112, v114
    v_subrev_u32 v115, 90112, v115
    v_subrev_u32 v116, 90112, v116
    v_subrev_u32 v117, 90112, v117
    v_subrev_u32 v118, 90112, v118
    v_subrev_u32 v119, 90112, v119
    s_waitcnt vmcnt(4)
    v_cmp_ne_u32 vcc, s35, v111
    s_nop 1
    s_cbranch_vccz L_polldck
L_pollck:
    buffer_load_dword v111, v110, s[64:67], s101 offen sc1
    s_waitcnt vmcnt(0)
    v_cmp_ne_u32 vcc, s35, v111
    s_nop 1
    s_cbranch_vccz L_polldck
    s_nop 0
    s_add_u32 s31, s31, 1
    s_cmp_lt_u32 s31, 0x8000
    s_cbranch_scc1 L_pollck
L_polldck:
    s_lshl_b32 s8, s6, 2
    s_add_u32 s8, s8, s68
    s_lshl_b32 s8, s8, 9
    s_add_u32 s34, s8, 11927552
    v_and_b32 v122, 31, v140
    v_lshlrev_b32 v122, 4, v122
    buffer_load_dwordx4 v[104:107], v122, s[64:67], s34 offen sc1
    s_waitcnt lgkmcnt(0)
    s_barrier
    ds_read_b64_tr_b16 v[64:65], v116 offset:0
    ds_read_b64_tr_b16 v[66:67], v116 offset:1792
    buffer_load_dwordx4 a[32:35], v108, s[64:67], s30 offen offset:0 sc1
    buffer_load_dwordx4 a[36:39], v108, s[64:67], s30 offen offset:448 sc1
    buffer_load_dwordx4 a[40:43], v108, s[64:67], s30 offen offset:896 sc1
    v_mfma_f32_32x32x16_bf16 v[0:15], v[84:87], v[100:103], v[0:15]
    ds_read_b64_tr_b16 v[68:69], v116 offset:56
    ds_read_b64_tr_b16 v[70:71], v116 offset:1848
    ds_read_b128 v[96:99], v112
    buffer_load_dword v59, v58, s[64:67], s24 offen sc1
    v_mfma_f32_32x32x16_bf16 v[16:31], v[88:91], v[100:103], v[16:31]
    ds_read_b64_tr_b16 v[72:73], v116 offset:112
    ds_read_b64_tr_b16 v[74:75], v116 offset:1904
    v_mfma_f32_32x32x16_bf16 v[32:47], v[92:95], v[100:103], v[32:47]
    ds_read_b64_tr_b16 v[76:77], v117 offset:56
    ds_read_b64_tr_b16 v[78:79], v117 offset:1848
    s_waitcnt lgkmcnt(4)
    v_mfma_f32_32x32x16_bf16 v[0:15], v[64:67], v[96:99], v[0:15]
    ds_read_b64_tr_b16 v[80:81], v117 offset:112
    ds_read_b64_tr_b16 v[82:83], v117 offset:1904
    ds_read_b128 v[100:103], v113
    s_add_u32 m0, s19, 32768
    s_add_u32 s8, s18, 28672
    buffer_load_dwordx4 v139, s[52:55], s8 offen lds
    buffer_load_dwordx4 v125, s[52:55], s8 offen offset:1024 lds
    v_mfma_f32_32x32x16_bf16 v[16:31], v[68:71], v[96:99], v[16:31]
    ds_read_b64_tr_b16 v[84:85], v117 offset:0
    ds_read_b64_tr_b16 v[86:87], v117 offset:1792
    s_waitcnt lgkmcnt(5)
    v_mfma_f32_32x32x16_bf16 v[32:47], v[72:75], v[96:99], v[32:47]
    ds_read_b64_tr_b16 v[88:89], v118 offset:112
    ds_read_b64_tr_b16 v[90:91], v118 offset:1904
    s_waitcnt lgkmcnt(4)
    v_mfma_f32_32x32x16_bf16 v[16:31], v[76:79], v[100:103], v[16:31]
    ds_read_b64_tr_b16 v[92:93], v118 offset:0
    ds_read_b64_tr_b16 v[94:95], v118 offset:1792
    ds_read_b128 v[96:99], v114
    s_add_u32 m0, s19, 34816
    s_add_u32 s8, s18, 43008
    buffer_load_dwordx4 v139, s[52:55], s8 offen lds
    buffer_load_dwordx4 v125, s[52:55], s8 offen offset:1024 lds
    s_waitcnt lgkmcnt(5)
    v_mfma_f32_32x32x16_bf16 v[32:47], v[80:83], v[100:103], v[32:47]
    ds_read_b64_tr_b16 v[64:65], v118 offset:56
    ds_read_b64_tr_b16 v[66:67], v118 offset:1848
    v_mfma_f32_32x32x16_bf16 v[0:15], v[84:87], v[100:103], v[0:15]
    ds_read_b64_tr_b16 v[68:69], v119 offset:0
    ds_read_b64_tr_b16 v[70:71], v119 offset:1792
    s_waitcnt lgkmcnt(4)
    v_mfma_f32_32x32x16_bf16 v[32:47], v[88:91], v[96:99], v[32:47]
    ds_read_b64_tr_b16 v[72:73], v119 offset:56
    ds_read_b64_tr_b16 v[74:75], v119 offset:1848
    ds_read_b128 v[100:103], v115
    v_mfma_f32_32x32x16_bf16 v[0:15], v[92:95], v[96:99], v[0:15]
    ds_read_b64_tr_b16 v[76:77], v119 offset:112
    ds_read_b64_tr_b16 v[78:79], v119 offset:1904
    s_waitcnt lgkmcnt(5)
    v_mfma_f32_32x32x16_bf16 v[16:31], v[64:67], v[96:99], v[16:31]
    s_waitcnt lgkmcnt(2)
    v_mfma_f32_32x32x16_bf16 v[0:15], v[68:71], v[100:103], v[0:15]
    s_waitcnt lgkmcnt(0)
    v_mfma_f32_32x32x16_bf16 v[16:31], v[72:75], v[100:103], v[16:31]
    v_mfma_f32_32x32x16_bf16 v[32:47], v[76:79], v[100:103], v[32:47]
    s_lshl_b32 s25, s4, 11
    s_add_u32 s25, s25, 144384
    s_sub_u32 s8, s25, s19
    v_add_u32 v126, s8, v142
    v_add_u32 v127, s8, v143
    s_waitcnt vmcnt(8)
    v_cmp_ne_u32 vcc, s35, v106
    s_nop 1
    s_cbranch_vccz L_gotrk
L_spinrk:
    buffer_load_dwordx4 v[104:107], v122, s[64:67], s34 offen sc1
    s_waitcnt vmcnt(0)
    v_cmp_ne_u32 vcc, s35, v106
    s_nop 1
    s_cbranch_vccz L_gotrk
    s_nop 0
    s_add_u32 s31, s31, 1
    s_cmp_lt_u32 s31, 0x8000
    s_cbranch_scc1 L_spinrk
L_gotrk:
    v_cvt_pk_bf16_f32 v96, v104, v104
    v_cvt_pk_bf16_f32 v97, v104, v104
    v_cvt_pk_bf16_f32 v98, v104, v104
    v_cvt_pk_bf16_f32 v99, v104, v104
    v_mul_f32 v104, 0x3fb8aa3b, v105
    s_waitcnt vmcnt(7)
    v_mfma_f32_32x32x16_bf16 v[0:15], a[32:35], v[96:99], v[0:15]
    s_waitcnt vmcnt(6)
    v_mfma_f32_32x32x16_bf16 v[16:31], a[36:39], v[96:99], v[16:31]
    s_waitcnt vmcnt(5)
    v_mfma_f32_32x32x16_bf16 v[32:47], a[40:43], v[96:99], v[32:47]
    s_barrier
    s_cmp_eq_u32 s69, 1
    s_cbranch_scc1 L_kv_v
L_kv_k:
    s_nop 4
    v_cvt_pk_bf16_f32 v80, v0, v1
    v_cvt_pk_bf16_f32 v81, v2, v3
    v_cvt_pk_bf16_f32 v82, v4, v5
    v_cvt_pk_bf16_f32 v83, v6, v7
    v_cvt_pk_bf16_f32 v84, v8, v9
    v_cvt_pk_bf16_f32 v85, v10, v11
    v_cvt_pk_bf16_f32 v86, v12, v13
    v_cvt_pk_bf16_f32 v87, v14, v15
    v_cndmask_b32 v86, v86, 0, s[28:29]
    v_cndmask_b32 v87, v87, 0, s[28:29]
    ds_write_b128 v50, v[80:83] offset:0
    ds_write_b128 v50, v[84:87] offset:1024
    v_cvt_pk_bf16_f32 v88, v16, v17
    v_cvt_pk_bf16_f32 v89, v18, v19
    v_cvt_pk_bf16_f32 v90, v20, v21
    v_cvt_pk_bf16_f32 v91, v22, v23
    v_cvt_pk_bf16_f32 v92, v24, v25
    v_cvt_pk_bf16_f32 v93, v26, v27
    v_cvt_pk_bf16_f32 v94, v28, v29
    v_cvt_pk_bf16_f32 v95, v30, v31
    v_cndmask_b32 v94, v94, 0, s[28:29]
    v_cndmask_b32 v95, v95, 0, s[28:29]
    ds_write_b128 v50, v[88:91] offset:8192
    ds_write_b128 v50, v[92:95] offset:9216
    v_cvt_pk_bf16_f32 v96, v32, v33
    v_cvt_pk_bf16_f32 v97, v34, v35
    v_cvt_pk_bf16_f32 v98, v36, v37
    v_cvt_pk_bf16_f32 v99, v38, v39
    v_cvt_pk_bf16_f32 v100, v40, v41
    v_cvt_pk_bf16_f32 v101, v42, v43
    v_cvt_pk_bf16_f32 v102, v44, v45
    v_cvt_pk_bf16_f32 v103, v46, v47
    v_cndmask_b32 v102, v102, 0, s[28:29]
    v_cndmask_b32 v103, v103, 0, s[28:29]
    ds_write_b128 v50, v[96:99] offset:16384
    ds_write_b128 v50, v[100:103] offset:17408
    s_waitcnt lgkmcnt(0)
    s_barrier
    v_mfma_f32_32x32x16_bf16 v[0:15], a[88:91], v[80:83], 0
    v_mfma_f32_32x32x16_bf16 v[0:15], a[92:95], v[84:87], v[0:15]
    v_mfma_f32_32x32x16_bf16 v[16:31], a[96:99], v[88:91], 0
    v_mfma_f32_32x32x16_bf16 v[16:31], a[100:103], v[92:95], v[16:31]
    v_mfma_f32_32x32x16_bf16 v[32:47], a[104:107], v[96:99], 0
    v_mfma_f32_32x32x16_bf16 v[32:47], a[108:111], v[100:103], v[32:47]
    s_waitcnt vmcnt(4)
    v_cmp_ne_u32 vcc, s35, v59
    s_nop 1
    s_cbranch_vccz L_polldzk
L_pollzk:
    buffer_load_dword v59, v58, s[64:67], s24 offen sc1
    s_waitcnt vmcnt(0)
    v_cmp_ne_u32 vcc, s35, v59
    s_nop 1
    s_cbranch_vccz L_polldzk
    s_nop 0
    s_add_u32 s31, s31, 1
    s_cmp_lt_u32 s31, 0x8000
    s_cbranch_scc1 L_pollzk
L_polldzk:
    s_add_u32 s10, s0, 4096
    s_lshr_b32 s11, s4, 1
    v_mov_b32 v138, 0xff800000
    v_max3_f32 v64, v0, v1, v2
    v_max3_f32 v65, v8, v9, v10
    v_max3_f32 v70, v16, v17, v18
    v_max3_f32 v71, v24, v25, v26
    v_max3_f32 v64, v64, v3, v4
    v_max3_f32 v65, v65, v11, v12
    v_max3_f32 v70, v70, v19, v20
    v_max3_f32 v71, v71, v27, v28
    v_max3_f32 v64, v64, v5, v6
    v_max3_f32 v65, v65, v13, v14
    v_max3_f32 v70, v70, v21, v22
    v_max3_f32 v71, v71, v29, v30
    v_max3_f32 v65, v65, v7, v15
    v_max3_f32 v71, v71, v23, v31
    v_max_f32 v64, v64, v65
    v_max_f32 v70, v70, v71
    v_mov_b32 v65, v64
    v_mov_b32 v71, v70
    s_nop 0
    v_permlane32_swap_b32 v64, v65
    ds_read_b64_tr_b16 a[0:1], v142 offset:0
    ds_read_b64_tr_b16 a[2:3], v142 offset:1024
    ds_read_b64_tr_b16 a[4:5], v143 offset:0
    ds_read_b64_tr_b16 a[6:7], v143 offset:1024
    ds_read_b64_tr_b16 a[8:9], v142 offset:2048
    ds_read_b64_tr_b16 a[10:11], v142 offset:3072
    ds_read_b64_tr_b16 a[12:13], v143 offset:2048
    ds_read_b64_tr_b16 a[14:15], v143 offset:3072
    s_waitcnt vmcnt(2)
    ds_read_b64_tr_b16 a[16:17], v142 offset:32768
    ds_read_b64_tr_b16 a[18:19], v142 offset:33792
    ds_read_b64_tr_b16 a[20:21], v143 offset:32768
    ds_read_b64_tr_b16 a[22:23], v143 offset:33792
    s_waitcnt vmcnt(0)
    ds_read_b64_tr_b16 a[24:25], v142 offset:34816
    ds_read_b64_tr_b16 a[26:27], v142 offset:35840
    ds_read_b64_tr_b16 a[28:29], v143 offset:34816
    ds_read_b64_tr_b16 a[30:31], v143 offset:35840
    v_permlane32_swap_b32 v70, v71
    v_max_f32 v64, v64, v65
    v_max_f32_e64 v70, v70, v71
    v_mul_f32 v64, -v104, v64
    v_mul_f32 v70, -v104, v70
    v_cndmask_b32 v65, v64, v138, s[28:29]
    v_cndmask_b32 v71, v70, v138, s[28:29]
    v_pk_fma_f32 v[0:1], v[0:1], v[104:105], v[64:65] op_sel_hi:[1,0,0]
    v_pk_fma_f32 v[16:17], v[16:17], v[104:105], v[70:71] op_sel_hi:[1,0,0]
    v_pk_fma_f32 v[2:3], v[2:3], v[104:105], v[64:65] op_sel_hi:[1,0,0]
    v_pk_fma_f32 v[18:19], v[18:19], v[104:105], v[70:71] op_sel_hi:[1,0,0]
    v_pk_fma_f32 v[4:5], v[4:5], v[104:105], v[64:65] op_sel_hi:[1,0,0]
    v_pk_fma_f32 v[20:21], v[20:21], v[104:105], v[70:71] op_sel_hi:[1,0,0]
    v_pk_fma_f32 v[6:7], v[6:7], v[104:105], v[64:65] op_sel_hi:[1,0,0]
    v_pk_fma_f32 v[22:23], v[22:23], v[104:105], v[70:71] op_sel_hi:[1,0,0]
    v_pk_fma_f32 v[8:9], v[8:9], v[104:105], v[64:65] op_sel_hi:[1,0,0]
    v_pk_fma_f32 v[24:25], v[24:25], v[104:105], v[70:71] op_sel_hi:[1,0,0]
    v_pk_fma_f32 v[10:11], v[10:11], v[104:105], v[64:65] op_sel_hi:[1,0,0]
    v_pk_fma_f32 v[26:27], v[26:27], v[104:105], v[70:71] op_sel_hi:[1,0,0]
    v_pk_fma_f32 v[12:13], v[12:13], v[104:105], v[64:65] op_sel:[0,0,1] op_sel_hi:[1,0,1]
    s_add_u32 m0, s19, 0
    s_add_u32 s8, s18, 71680
    s_waitcnt lgkmcnt(12)
    buffer_load_dwordx4 v139, s[52:55], s8 offen lds
    buffer_load_dwordx4 v125, s[52:55], s8 offen offset:1024 lds
    v_pk_fma_f32 v[28:29], v[28:29], v[104:105], v[70:71] op_sel:[0,0,1] op_sel_hi:[1,0,1]
    v_pk_fma_f32 v[14:15], v[14:15], v[104:105], v[64:65] op_sel:[0,0,1] op_sel_hi:[1,0,1]
    v_pk_fma_f32 v[30:31], v[30:31], v[104:105], v[70:71] op_sel:[0,0,1] op_sel_hi:[1,0,1]
    v_exp_f32 v0, v0
    v_exp_f32 v16, v16
    v_exp_f32 v1, v1
    v_exp_f32 v17, v17
    v_exp_f32 v2, v2
    v_exp_f32 v18, v18
    v_exp_f32 v3, v3
    v_exp_f32 v19, v19
    v_exp_f32 v4, v4
    v_exp_f32 v20, v20
    v_exp_f32 v5, v5
    v_exp_f32 v21, v21
    v_exp_f32 v6, v6
    v_exp_f32 v22, v22
    v_exp_f32 v7, v7
    v_exp_f32 v23, v23
    v_exp_f32 v8, v8
    s_add_u32 m0, s19, 2048
    s_add_u32 s8, s18, 86016
    s_waitcnt lgkmcnt(8)
    buffer_load_dwordx4 v139, s[52:55], s8 offen lds
    buffer_load_dwordx4 v125, s[52:55], s8 offen offset:1024 lds
    v_exp_f32 v24, v24
    v_exp_f32 v9, v9
    v_exp_f32 v25, v25
    v_exp_f32 v10, v10
    v_exp_f32 v26, v26
    v_exp_f32 v11, v11
    v_exp_f32 v27, v27
    v_exp_f32 v12, v12
    v_exp_f32 v28, v28
    v_exp_f32 v13, v13
    v_exp_f32 v29, v29
    v_exp_f32 v14, v14
    v_exp_f32 v30, v30
    v_exp_f32 v15, v15
    v_exp_f32_e64 v31, v31
    v_pk_add_f32 v[66:67], v[0:1], v[2:3]
    v_pk_add_f32 v[68:69], v[8:9], v[10:11]
    v_pk_add_f32 v[72:73], v[16:17], v[18:19]
    v_pk_add_f32 v[74:75], v[24:25], v[26:27]
    v_pk_add_f32 v[66:67], v[66:67], v[4:5]
    s_add_u32 m0, s19, 32768
    s_add_u32 s8, s18, 100352
    s_waitcnt lgkmcnt(4)
    buffer_load_dwordx4 v139, s[52:55], s8 offen lds
    buffer_load_dwordx4 v125, s[52:55], s8 offen offset:1024 lds
    v_pk_add_f32 v[68:69], v[68:69], v[12:13]
    v_pk_add_f32 v[72:73], v[72:73], v[20:21]
    v_pk_add_f32 v[74:75], v[74:75], v[28:29]
    v_pk_add_f32 v[66:67], v[66:67], v[6:7]
    v_pk_add_f32 v[68:69], v[68:69], v[14:15]
    v_pk_add_f32 v[72:73], v[72:73], v[22:23]
    v_pk_add_f32 v[74:75], v[74:75], v[30:31]
    v_pk_add_f32 v[66:67], v[66:67], v[68:69]
    v_pk_add_f32 v[72:73], v[72:73], v[74:75]
    v_add_f32 v64, v66, v67
    v_add_f32 v70, v72, v73
    v_mov_b32 v65, v64
    v_mov_b32 v71, v70
    s_nop 0
    v_permlane32_swap_b32 v64, v65
    v_permlane32_swap_b32 v70, v71
    v_add_f32 v64, v64, v65
    v_add_f32 v70, v70, v71
    v_rcp_f32 v64, v64
    v_rcp_f32 v70, v70
    v_pk_mul_f32 v[0:1], v[0:1], v[64:65] op_sel_hi:[1,0]
    s_add_u32 m0, s19, 34816
    s_add_u32 s8, s18, 114688
    s_waitcnt lgkmcnt(0)
    buffer_load_dwordx4 v139, s[52:55], s8 offen lds
    buffer_load_dwordx4 v125, s[52:55], s8 offen offset:1024 lds
    s_nop 0
    v_pk_mul_f32 v[16:17], v[16:17], v[70:71] op_sel_hi:[1,0]
    v_pk_mul_f32 v[2:3], v[2:3], v[64:65] op_sel_hi:[1,0]
    v_pk_mul_f32 v[18:19], v[18:19], v[70:71] op_sel_hi:[1,0]
    v_pk_mul_f32 v[4:5], v[4:5], v[64:65] op_sel_hi:[1,0]
    v_pk_mul_f32 v[20:21], v[20:21], v[70:71] op_sel_hi:[1,0]
    v_pk_mul_f32 v[6:7], v[6:7], v[64:65] op_sel_hi:[1,0]
    v_pk_mul_f32 v[22:23], v[22:23], v[70:71] op_sel_hi:[1,0]
    v_pk_mul_f32 v[8:9], v[8:9], v[64:65] op_sel_hi:[1,0]
    v_pk_mul_f32 v[24:25], v[24:25], v[70:71] op_sel_hi:[1,0]
    v_pk_mul_f32 v[10:11], v[10:11], v[64:65] op_sel_hi:[1,0]
    v_pk_mul_f32 v[26:27], v[26:27], v[70:71] op_sel_hi:[1,0]
    v_pk_mul_f32 v[12:13], v[12:13], v[64:65] op_sel_hi:[1,0]
    v_pk_mul_f32 v[28:29], v[28:29], v[70:71] op_sel_hi:[1,0]
    v_pk_mul_f32 v[14:15], v[14:15], v[64:65] op_sel_hi:[1,0]
    v_pk_mul_f32 v[30:31], v[30:31], v[70:71] op_sel_hi:[1,0]
    v_cvt_pk_bf16_f32 v0, v0, v1
    v_cvt_pk_bf16_f32 v16, v16, v17
    v_cvt_pk_bf16_f32 v1, v2, v3
    v_cvt_pk_bf16_f32 v17, v18, v19
    v_cvt_pk_bf16_f32 v2, v4, v5
    v_cvt_pk_bf16_f32 v18, v20, v21
    v_cvt_pk_bf16_f32 v3, v6, v7
    v_cvt_pk_bf16_f32 v19, v22, v23
    v_cvt_pk_bf16_f32 v4, v8, v9
    v_cvt_pk_bf16_f32 v20, v24, v25
    v_cvt_pk_bf16_f32 v5, v10, v11
    v_cvt_pk_bf16_f32 v21, v26, v27
    v_cvt_pk_bf16_f32 v6, v12, v13
    v_cvt_pk_bf16_f32 v22, v28, v29
    v_cvt_pk_bf16_f32 v7, v14, v15
    v_cvt_pk_bf16_f32 v23, v30, v31
    ds_write_b128 v48, v[0:3] offset:0
    ds_write_b128 v49, v[4:7] offset:0
    ds_write_b128 v48, v[16:19] offset:16384
    ds_write_b128 v49, v[20:23] offset:16384
    s_waitcnt lgkmcnt(0)
    s_barrier
    ds_read_b64_tr_b16 v[80:81], v51 offset:0
    ds_read_b64_tr_b16 v[84:85], v52 offset:0
    ds_read_b64_tr_b16 v[82:83], v51 offset:512
    ds_read_b64_tr_b16 v[86:87], v52 offset:512
    ds_read_b64_tr_b16 v[88:89], v51 offset:1024
    ds_read_b64_tr_b16 v[92:93], v52 offset:1024
    ds_read_b64_tr_b16 v[90:91], v51 offset:1536
    ds_read_b64_tr_b16 v[94:95], v52 offset:1536
    ds_read_b64_tr_b16 v[96:97], v51 offset:2048
    ds_read_b64_tr_b16 v[100:101], v52 offset:2048
    ds_read_b64_tr_b16 v[98:99], v51 offset:2560
    ds_read_b64_tr_b16 v[102:103], v52 offset:2560
    ds_read_b64_tr_b16 v[112:113], v51 offset:3072
    ds_read_b64_tr_b16 v[116:117], v52 offset:3072
    ds_read_b64_tr_b16 v[114:115], v51 offset:3584
    ds_read_b64_tr_b16 v[118:119], v52 offset:3584
    s_waitcnt lgkmcnt(12)
    v_mfma_f32_32x32x16_bf16 v[0:15], v[80:83], v[84:87], 0
    ds_read_b64_tr_b16 v[80:81], v51 offset:4096
    ds_read_b64_tr_b16 v[84:85], v52 offset:4096
    ds_read_b64_tr_b16 v[82:83], v51 offset:4608
    ds_read_b64_tr_b16 v[86:87], v52 offset:4608
    s_waitcnt lgkmcnt(12)
    v_mfma_f32_32x32x16_bf16 v[0:15], v[88:91], v[92:95], v[0:15]
    ds_read_b64_tr_b16 v[88:89], v51 offset:5120
    ds_read_b64_tr_b16 v[92:93], v52 offset:5120
    ds_read_b64_tr_b16 v[90:91], v51 offset:5632
    ds_read_b64_tr_b16 v[94:95], v52 offset:5632
    s_waitcnt lgkmcnt(12)
    v_mfma_f32_32x32x16_bf16 v[0:15], v[96:99], v[100:103], v[0:15]
    ds_read_b64_tr_b16 v[96:97], v51 offset:6144
    ds_read_b64_tr_b16 v[100:101], v52 offset:6144
    ds_read_b64_tr_b16 v[98:99], v51 offset:6656
    ds_read_b64_tr_b16 v[102:103], v52 offset:6656
    s_waitcnt lgkmcnt(12)
    v_mfma_f32_32x32x16_bf16 v[0:15], v[112:115], v[116:119], v[0:15]
    ds_read_b64_tr_b16 v[112:113], v51 offset:7168
    ds_read_b64_tr_b16 v[116:117], v52 offset:7168
    ds_read_b64_tr_b16 v[114:115], v51 offset:7680
    ds_read_b64_tr_b16 v[118:119], v52 offset:7680
    s_waitcnt lgkmcnt(12)
    v_mfma_f32_32x32x16_bf16 v[0:15], v[80:83], v[84:87], v[0:15]
    s_waitcnt lgkmcnt(8)
    v_mfma_f32_32x32x16_bf16 v[0:15], v[88:91], v[92:95], v[0:15]
    s_waitcnt lgkmcnt(4)
    v_mfma_f32_32x32x16_bf16 v[0:15], v[96:99], v[100:103], v[0:15]
    s_waitcnt lgkmcnt(0)
    v_mfma_f32_32x32x16_bf16 v[0:15], v[112:115], v[116:119], v[0:15]
    v_mov_b32 v138, 0xff800000
    v_max3_f32 v64, v32, v33, v34
    v_max3_f32 v65, v40, v41, v42
    v_max3_f32 v64, v64, v35, v36
    s_nop 7
    buffer_atomic_add_f32 v0, v53, s[64:67], s0 offen offset:0
    v_max3_f32 v65, v65, v43, v44
    v_max3_f32 v64, v64, v37, v38
    v_max3_f32 v65, v65, v45, v46
    v_max3_f32 v65, v65, v39, v47
    buffer_atomic_add_f32 v1, v53, s[64:67], s0 offen offset:256
    v_max_f32 v64, v64, v65
    v_mov_b32 v65, v64
    s_nop 1
    v_permlane32_swap_b32 v64, v65
    v_max_f32 v64, v64, v65
    buffer_atomic_add_f32 v2, v53, s[64:67], s0 offen offset:512
    v_mul_f32 v64, -v104, v64
    v_cndmask_b32 v65, v64, v138, s[28:29]
    v_pk_fma_f32 v[32:33], v[32:33], v[104:105], v[64:65] op_sel_hi:[1,0,0]
    v_pk_fma_f32 v[34:35], v[34:35], v[104:105], v[64:65] op_sel_hi:[1,0,0]
    buffer_atomic_add_f32 v3, v53, s[64:67], s0 offen offset:768
    v_pk_fma_f32 v[36:37], v[36:37], v[104:105], v[64:65] op_sel_hi:[1,0,0]
    v_pk_fma_f32 v[38:39], v[38:39], v[104:105], v[64:65] op_sel_hi:[1,0,0]
    v_pk_fma_f32 v[40:41], v[40:41], v[104:105], v[64:65] op_sel_hi:[1,0,0]
    v_pk_fma_f32 v[42:43], v[42:43], v[104:105], v[64:65] op_sel_hi:[1,0,0]
    buffer_atomic_add_f32 v4, v53, s[64:67], s0 offen offset:2048
    v_pk_fma_f32 v[44:45], v[44:45], v[104:105], v[64:65] op_sel:[0,0,1] op_sel_hi:[1,0,1]
    v_pk_fma_f32 v[46:47], v[46:47], v[104:105], v[64:65] op_sel:[0,0,1] op_sel_hi:[1,0,1]
    v_exp_f32 v32, v32
    v_exp_f32 v33, v33
    buffer_atomic_add_f32 v5, v53, s[64:67], s0 offen offset:2304
    v_exp_f32 v34, v34
    v_exp_f32 v35, v35
    v_exp_f32 v36, v36
    v_exp_f32 v37, v37
    buffer_atomic_add_f32 v6, v53, s[64:67], s0 offen offset:2560
    v_exp_f32 v38, v38
    v_exp_f32 v39, v39
    v_exp_f32 v40, v40
    v_exp_f32 v41, v41
    buffer_atomic_add_f32 v7, v53, s[64:67], s0 offen offset:2816
    v_exp_f32 v42, v42
    v_exp_f32 v43, v43
    v_exp_f32 v44, v44
    v_exp_f32 v45, v45
    buffer_atomic_add_f32 v8, v53, s[64:67], s10 offen offset:0
    v_exp_f32 v46, v46
    v_exp_f32 v47, v47
    v_pk_add_f32 v[66:67], v[32:33], v[34:35]
    v_pk_add_f32 v[68:69], v[40:41], v[42:43]
    buffer_atomic_add_f32 v9, v53, s[64:67], s10 offen offset:256
    v_pk_add_f32 v[66:67], v[66:67], v[36:37]
    v_pk_add_f32 v[68:69], v[68:69], v[44:45]
    v_pk_add_f32 v[66:67], v[66:67], v[38:39]
    v_pk_add_f32 v[68:69], v[68:69], v[46:47]
    buffer_atomic_add_f32 v10, v53, s[64:67], s10 offen offset:512
    v_pk_add_f32 v[66:67], v[66:67], v[68:69]
    v_add_f32 v64, v66, v67
    v_mov_b32 v65, v64
    s_nop 1
    v_permlane32_swap_b32 v64, v65
    buffer_atomic_add_f32 v11, v53, s[64:67], s10 offen offset:768
    v_add_f32 v64, v64, v65
    v_rcp_f32_e64 v64, v64
    s_nop 0
    v_pk_mul_f32 v[32:33], v[32:33], v[64:65] op_sel_hi:[1,0]
    v_pk_mul_f32 v[34:35], v[34:35], v[64:65] op_sel_hi:[1,0]
    buffer_atomic_add_f32 v12, v53, s[64:67], s10 offen offset:2048
    v_pk_mul_f32 v[36:37], v[36:37], v[64:65] op_sel_hi:[1,0]
    v_pk_mul_f32 v[38:39], v[38:39], v[64:65] op_sel_hi:[1,0]
    v_pk_mul_f32 v[40:41], v[40:41], v[64:65] op_sel_hi:[1,0]
    v_pk_mul_f32 v[42:43], v[42:43], v[64:65] op_sel_hi:[1,0]
    buffer_atomic_add_f32 v13, v53, s[64:67], s10 offen offset:2304
    v_pk_mul_f32 v[44:45], v[44:45], v[64:65] op_sel_hi:[1,0]
    v_pk_mul_f32 v[46:47], v[46:47], v[64:65] op_sel_hi:[1,0]
    v_cvt_pk_bf16_f32 v32, v32, v33
    v_cvt_pk_bf16_f32 v33, v34, v35
    s_mov_b32 exec_hi, 0
    buffer_atomic_add_f32 v14, v53, s[64:67], s10 offen offset:2560
    buffer_atomic_add_f32 v15, v53, s[64:67], s10 offen offset:2816
    s_mov_b64 exec, -1
    v_cvt_pk_bf16_f32 v34, v36, v37
    v_cvt_pk_bf16_f32 v35, v38, v39
    v_cvt_pk_bf16_f32 v36, v40, v41
    v_cvt_pk_bf16_f32 v37, v42, v43
    v_cvt_pk_bf16_f32 v38, v44, v45
    v_cvt_pk_bf16_f32 v39, v46, v47
    ds_write_b128 v48, v[32:35] offset:32768
    ds_write_b128 v49, v[36:39] offset:32768
    s_waitcnt lgkmcnt(0)
    s_barrier
L_nounitk:
    s_waitcnt vmcnt(0)
    s_barrier
    s_cmp_lg_u32 s4, 7
    s_cbranch_scc1 L_nokfk
    v_mov_b32 v96, s35
    v_mov_b32 v97, 0
    s_mov_b64 exec, 1
    buffer_store_dword v96, v97, s[64:67], s1 offen sc1
    s_mov_b64 exec, -1
L_nokfk:
    s_setprio 0
    ds_read_b64_tr_b16 a[40:41], v142 offset:0
    ds_read_b64_tr_b16 a[42:43], v142 offset:1024
    ds_read_b64_tr_b16 a[44:45], v143 offset:0
    ds_read_b64_tr_b16 a[46:47], v143 offset:1024
    ds_read_b64_tr_b16 a[48:49], v142 offset:2048
    ds_read_b64_tr_b16 a[50:51], v142 offset:3072
    ds_read_b64_tr_b16 a[52:53], v143 offset:2048
    ds_read_b64_tr_b16 a[54:55], v143 offset:3072
    ds_read_b64_tr_b16 a[56:57], v142 offset:32768
    ds_read_b64_tr_b16 a[58:59], v142 offset:33792
    ds_read_b64_tr_b16 a[60:61], v143 offset:32768
    ds_read_b64_tr_b16 a[62:63], v143 offset:33792
    ds_read_b64_tr_b16 a[64:65], v142 offset:34816
    ds_read_b64_tr_b16 a[66:67], v142 offset:35840
    ds_read_b64_tr_b16 a[68:69], v143 offset:34816
    ds_read_b64_tr_b16 a[70:71], v143 offset:35840
    s_mov_b32 m0, s25
    s_add_u32 s8, s18, 57344
    buffer_load_dwordx4 v139, s[52:55], s8 offen lds
    buffer_load_dwordx4 v125, s[52:55], s8 offen offset:1024 lds
    s_add_u32 m0, s19, 0
    s_add_u32 s8, s18, 143360
    s_waitcnt lgkmcnt(12)
    buffer_load_dwordx4 v139, s[52:55], s8 offen lds
    buffer_load_dwordx4 v125, s[52:55], s8 offen offset:1024 lds
    s_add_u32 m0, s19, 2048
    s_add_u32 s8, s18, 157696
    s_waitcnt lgkmcnt(8)
    buffer_load_dwordx4 v139, s[52:55], s8 offen lds
    buffer_load_dwordx4 v125, s[52:55], s8 offen offset:1024 lds
    v_accvgpr_read_b32 v129, a72
    v_accvgpr_read_b32 v130, a73
    v_accvgpr_read_b32 v131, a74
    v_accvgpr_read_b32 v136, a75
    v_accvgpr_read_b32 v137, a76
    v_accvgpr_read_b32 v138, a77
    buffer_load_dword v128, v129, s[64:67], s98 offen sc1
    s_add_u32 m0, s19, 32768
    s_add_u32 s8, s18, 172032
    s_waitcnt lgkmcnt(4)
    buffer_load_dwordx4 v139, s[52:55], s8 offen lds
    buffer_load_dwordx4 v125, s[52:55], s8 offen offset:1024 lds
    s_add_u32 m0, s19, 34816
    s_add_u32 s8, s18, 186368
    s_waitcnt lgkmcnt(0)
    buffer_load_dwordx4 v139, s[52:55], s8 offen lds
    buffer_load_dwordx4 v125, s[52:55], s8 offen offset:1024 lds
    s_waitcnt vmcnt(9)
    ds_read_b64_tr_b16 a[32:33], v126 offset:0
    ds_read_b64_tr_b16 a[34:35], v126 offset:1024
    ds_read_b64_tr_b16 a[36:37], v127 offset:0
    ds_read_b64_tr_b16 a[38:39], v127 offset:1024
    s_mov_b32 m0, s25
    s_add_u32 s8, s18, 129024
    s_waitcnt lgkmcnt(0)
    buffer_load_dwordx4 v139, s[52:55], s8 offen lds
    buffer_load_dwordx4 v125, s[52:55], s8 offen offset:1024 lds
    s_waitcnt lgkmcnt(0)
    s_waitcnt vmcnt(6)
    s_nop 0
    s_branch L_p2
L_kv_v:
    v_cndmask_b32 v108, v105, 0, s[28:29]
    v_cndmask_b32 v109, 0, 1.0, s[28:29]
    s_nop 2
    s_nop 0
    v_pk_mul_f32 v[0:1], v[0:1], v[104:105] op_sel:[0,1] op_sel_hi:[1,1]
    v_pk_mul_f32 v[2:3], v[2:3], v[104:105] op_sel:[0,1] op_sel_hi:[1,1]
    v_pk_mul_f32 v[4:5], v[4:5], v[104:105] op_sel:[0,1] op_sel_hi:[1,1]
    v_pk_mul_f32 v[6:7], v[6:7], v[104:105] op_sel:[0,1] op_sel_hi:[1,1]
    v_pk_mul_f32 v[8:9], v[8:9], v[104:105] op_sel:[0,1] op_sel_hi:[1,1]
    v_pk_mul_f32 v[10:11], v[10:11], v[104:105] op_sel:[0,1] op_sel_hi:[1,1]
    v_pk_fma_f32 v[12:13], v[12:13], v[108:109], v[108:109] op_sel:[0,0,1] op_sel_hi:[1,0,1]
    v_pk_fma_f32 v[14:15], v[14:15], v[108:109], v[108:109] op_sel:[0,0,1] op_sel_hi:[1,0,1]
    v_cvt_pk_bf16_f32 v88, v0, v1
    v_cvt_pk_bf16_f32 v89, v2, v3
    v_cvt_pk_bf16_f32 v90, v4, v5
    v_cvt_pk_bf16_f32 v91, v6, v7
    v_cvt_pk_bf16_f32 v92, v8, v9
    v_cvt_pk_bf16_f32 v93, v10, v11
    v_cvt_pk_bf16_f32 v94, v12, v13
    v_cvt_pk_bf16_f32 v95, v14, v15
    v_pk_mul_f32 v[16:17], v[16:17], v[104:105] op_sel:[0,1] op_sel_hi:[1,1]
    v_pk_mul_f32 v[18:19], v[18:19], v[104:105] op_sel:[0,1] op_sel_hi:[1,1]
    v_pk_mul_f32 v[20:21], v[20:21], v[104:105] op_sel:[0,1] op_sel_hi:[1,1]
    v_pk_mul_f32 v[22:23], v[22:23], v[104:105] op_sel:[0,1] op_sel_hi:[1,1]
    v_pk_mul_f32 v[24:25], v[24:25], v[104:105] op_sel:[0,1] op_sel_hi:[1,1]
    v_pk_mul_f32 v[26:27], v[26:27], v[104:105] op_sel:[0,1] op_sel_hi:[1,1]
    v_pk_fma_f32 v[28:29], v[28:29], v[108:109], v[108:109] op_sel:[0,0,1] op_sel_hi:[1,0,1]
    v_pk_fma_f32 v[30:31], v[30:31], v[108:109], v[108:109] op_sel:[0,0,1] op_sel_hi:[1,0,1]
    v_cvt_pk_bf16_f32 v96, v16, v17
    v_cvt_pk_bf16_f32 v97, v18, v19
    v_cvt_pk_bf16_f32 v98, v20, v21
    v_cvt_pk_bf16_f32 v99, v22, v23
    v_cvt_pk_bf16_f32 v100, v24, v25
    v_cvt_pk_bf16_f32 v101, v26, v27
    v_cvt_pk_bf16_f32 v102, v28, v29
    v_cvt_pk_bf16_f32 v103, v30, v31
    s_barrier
    ds_read_b128 v[64:67], v50 offset:0
    ds_read_b128 v[68:71], v50 offset:1024
    ds_read_b128 v[72:75], v50 offset:8192
    ds_read_b128 v[76:79], v50 offset:9216
    ds_read_b128 v[80:83], v50 offset:16384
    ds_read_b128 v[84:87], v50 offset:17408
    s_nop 0
    v_pk_mul_f32 v[32:33], v[32:33], v[104:105] op_sel:[0,1] op_sel_hi:[1,1]
    v_pk_mul_f32 v[34:35], v[34:35], v[104:105] op_sel:[0,1] op_sel_hi:[1,1]
    v_pk_mul_f32 v[36:37], v[36:37], v[104:105] op_sel:[0,1] op_sel_hi:[1,1]
    v_pk_mul_f32 v[38:39], v[38:39], v[104:105] op_sel:[0,1] op_sel_hi:[1,1]
    v_pk_mul_f32 v[40:41], v[40:41], v[104:105] op_sel:[0,1] op_sel_hi:[1,1]
    v_pk_mul_f32 v[42:43], v[42:43], v[104:105] op_sel:[0,1] op_sel_hi:[1,1]
    v_pk_fma_f32 v[44:45], v[44:45], v[108:109], v[108:109] op_sel:[0,0,1] op_sel_hi:[1,0,1]
    v_pk_fma_f32 v[46:47], v[46:47], v[108:109], v[108:109] op_sel:[0,0,1] op_sel_hi:[1,0,1]
    v_cvt_pk_bf16_f32 v112, v32, v33
    v_cvt_pk_bf16_f32 v113, v34, v35
    v_cvt_pk_bf16_f32 v114, v36, v37
    v_cvt_pk_bf16_f32 v115, v38, v39
    v_cvt_pk_bf16_f32 v116, v40, v41
    v_cvt_pk_bf16_f32 v117, v42, v43
    v_cvt_pk_bf16_f32 v118, v44, v45
    v_cvt_pk_bf16_f32 v119, v46, v47
    s_waitcnt lgkmcnt(5)
    v_mfma_f32_32x32x16_bf16 v[0:15], a[88:91], v[64:67], 0
    s_waitcnt lgkmcnt(4)
    v_mfma_f32_32x32x16_bf16 v[0:15], a[92:95], v[68:71], v[0:15]
    ds_write_b64 v54, v[88:89] offset:0
    ds_write_b64 v55, v[90:91] offset:0
    ds_write_b64 v56, v[92:93] offset:0
    ds_write_b64 v57, v[94:95] offset:0
    s_waitcnt lgkmcnt(7)
    v_mfma_f32_32x32x16_bf16 v[16:31], a[96:99], v[72:75], 0
    s_waitcnt lgkmcnt(6)
    v_mfma_f32_32x32x16_bf16 v[16:31], a[100:103], v[76:79], v[16:31]
    ds_write_b64 v54, v[96:97] offset:8192
    ds_write_b64 v55, v[98:99] offset:8192
    ds_write_b64 v56, v[100:101] offset:8192
    ds_write_b64 v57, v[102:103] offset:8192
    s_waitcnt lgkmcnt(9)
    v_mfma_f32_32x32x16_bf16 v[32:47], a[104:107], v[80:83], 0
    s_waitcnt lgkmcnt(8)
    v_mfma_f32_32x32x16_bf16 v[32:47], a[108:111], v[84:87], v[32:47]
    ds_write_b64 v54, v[112:113] offset:16384
    ds_write_b64 v55, v[114:115] offset:16384
    ds_write_b64 v56, v[116:117] offset:16384
    ds_write_b64 v57, v[118:119] offset:16384
    s_waitcnt vmcnt(4)
    v_cmp_ne_u32 vcc, s35, v59
    s_nop 1
    s_cbranch_vccz L_polldzv
L_pollzv:
    buffer_load_dword v59, v58, s[64:67], s24 offen sc1
    s_waitcnt vmcnt(0)
    v_cmp_ne_u32 vcc, s35, v59
    s_nop 1
    s_cbranch_vccz L_polldzv
    s_nop 0
    s_add_u32 s31, s31, 1
    s_cmp_lt_u32 s31, 0x8000
    s_cbranch_scc1 L_pollzv
L_polldzv:
    s_add_u32 s10, s0, 4096
    s_lshr_b32 s11, s4, 1
    v_mov_b32 v138, 0xff800000
    v_max3_f32 v64, -v0, -v1, -v2
    v_max3_f32 v65, -v8, -v9, -v10
    v_max3_f32 v70, -v16, -v17, -v18
    v_max3_f32 v71, -v24, -v25, -v26
    v_max3_f32 v64, v64, -v3, -v4
    v_max3_f32 v65, v65, -v11, -v12
    v_max3_f32 v70, v70, -v19, -v20
    v_max3_f32 v71, v71, -v27, -v28
    v_max3_f32 v64, v64, -v5, -v6
    v_max3_f32 v65, v65, -v13, -v14
    v_max3_f32 v70, v70, -v21, -v22
    v_max3_f32 v71, v71, -v29, -v30
    v_max3_f32 v65, v65, -v7, -v15
    v_max3_f32 v71, v71, -v23, -v31
    v_max_f32 v64, v64, v65
    v_max_f32 v70, v70, v71
    v_mov_b32 v65, v64
    v_mov_b32 v71, v70
    s_nop 0
    v_permlane32_swap_b32 v64, v65
    ds_read_b64_tr_b16 a[0:1], v142 offset:0
    ds_read_b64_tr_b16 a[2:3], v142 offset:1024
    ds_read_b64_tr_b16 a[4:5], v143 offset:0
    ds_read_b64_tr_b16 a[6:7], v143 offset:1024
    ds_read_b64_tr_b16 a[8:9], v142 offset:2048
    ds_read_b64_tr_b16 a[10:11], v142 offset:3072
    ds_read_b64_tr_b16 a[12:13], v143 offset:2048
    ds_read_b64_tr_b16 a[14:15], v143 offset:3072
    s_waitcnt vmcnt(2)
    ds_read_b64_tr_b16 a[16:17], v142 offset:32768
    ds_read_b64_tr_b16 a[18:19], v142 offset:33792
    ds_read_b64_tr_b16 a[20:21], v143 offset:32768
    ds_read_b64_tr_b16 a[22:23], v143 offset:33792
    s_waitcnt vmcnt(0)
    ds_read_b64_tr_b16 a[24:25], v142 offset:34816
    ds_read_b64_tr_b16 a[26:27], v142 offset:35840
    ds_read_b64_tr_b16 a[28:29], v143 offset:34816
    ds_read_b64_tr_b16 a[30:31], v143 offset:35840
    v_permlane32_swap_b32 v70, v71
    v_max_f32 v64, v64, v65
    v_max_f32_e64 v70, v70, v71
    v_mul_f32 v64, -v104, v64
    v_mul_f32 v70, -v104, v70
    v_cndmask_b32 v65, v64, v138, s[28:29]
    v_cndmask_b32 v71, v70, v138, s[28:29]
    v_pk_fma_f32 v[0:1], v[0:1], v[104:105], v[64:65] op_sel_hi:[1,0,0] neg_lo:[1,0,0] neg_hi:[1,0,0]
    v_pk_fma_f32 v[16:17], v[16:17], v[104:105], v[70:71] op_sel_hi:[1,0,0] neg_lo:[1,0,0] neg_hi:[1,0,0]
    v_pk_fma_f32 v[2:3], v[2:3], v[104:105], v[64:65] op_sel_hi:[1,0,0] neg_lo:[1,0,0] neg_hi:[1,0,0]
    v_pk_fma_f32 v[18:19], v[18:19], v[104:105], v[70:71] op_sel_hi:[1,0,0] neg_lo:[1,0,0] neg_hi:[1,0,0]
    v_pk_fma_f32 v[4:5], v[4:5], v[104:105], v[64:65] op_sel_hi:[1,0,0] neg_lo:[1,0,0] neg_hi:[1,0,0]
    v_pk_fma_f32 v[20:21], v[20:21], v[104:105], v[70:71] op_sel_hi:[1,0,0] neg_lo:[1,0,0] neg_hi:[1,0,0]
    v_pk_fma_f32 v[6:7], v[6:7], v[104:105], v[64:65] op_sel_hi:[1,0,0] neg_lo:[1,0,0] neg_hi:[1,0,0]
    v_pk_fma_f32 v[22:23], v[22:23], v[104:105], v[70:71] op_sel_hi:[1,0,0] neg_lo:[1,0,0] neg_hi:[1,0,0]
    v_pk_fma_f32 v[8:9], v[8:9], v[104:105], v[64:65] op_sel_hi:[1,0,0] neg_lo:[1,0,0] neg_hi:[1,0,0]
    v_pk_fma_f32 v[24:25], v[24:25], v[104:105], v[70:71] op_sel_hi:[1,0,0] neg_lo:[1,0,0] neg_hi:[1,0,0]
    v_pk_fma_f32 v[10:11], v[10:11], v[104:105], v[64:65] op_sel_hi:[1,0,0] neg_lo:[1,0,0] neg_hi:[1,0,0]
    v_pk_fma_f32 v[26:27], v[26:27], v[104:105], v[70:71] op_sel_hi:[1,0,0] neg_lo:[1,0,0] neg_hi:[1,0,0]
    v_pk_fma_f32 v[12:13], v[12:13], v[104:105], v[64:65] op_sel:[0,0,1] op_sel_hi:[1,0,1] neg_lo:[1,0,0] neg_hi:[1,0,0]
    s_add_u32 m0, s19, 0
    s_add_u32 s8, s18, 71680
    s_waitcnt lgkmcnt(12)
    buffer_load_dwordx4 v139, s[52:55], s8 offen lds
    buffer_load_dwordx4 v125, s[52:55], s8 offen offset:1024 lds
    v_pk_fma_f32 v[28:29], v[28:29], v[104:105], v[70:71] op_sel:[0,0,1] op_sel_hi:[1,0,1] neg_lo:[1,0,0] neg_hi:[1,0,0]
    v_pk_fma_f32 v[14:15], v[14:15], v[104:105], v[64:65] op_sel:[0,0,1] op_sel_hi:[1,0,1] neg_lo:[1,0,0] neg_hi:[1,0,0]
    v_pk_fma_f32 v[30:31], v[30:31], v[104:105], v[70:71] op_sel:[0,0,1] op_sel_hi:[1,0,1] neg_lo:[1,0,0] neg_hi:[1,0,0]
    v_exp_f32 v0, v0
    v_exp_f32 v16, v16
    v_exp_f32 v1, v1
    v_exp_f32 v17, v17
    v_exp_f32 v2, v2
    v_exp_f32 v18, v18
    v_exp_f32 v3, v3
    v_exp_f32 v19, v19
    v_exp_f32 v4, v4
    v_exp_f32 v20, v20
    v_exp_f32 v5, v5
    v_exp_f32 v21, v21
    v_exp_f32 v6, v6
    v_exp_f32 v22, v22
    v_exp_f32 v7, v7
    v_exp_f32 v23, v23
    v_exp_f32 v8, v8
    s_add_u32 m0, s19, 2048
    s_add_u32 s8, s18, 86016
    s_waitcnt lgkmcnt(8)
    buffer_load_dwordx4 v139, s[52:55], s8 offen lds
    buffer_load_dwordx4 v125, s[52:55], s8 offen offset:1024 lds
    v_exp_f32 v24, v24
    v_exp_f32 v9, v9
    v_exp_f32 v25, v25
    v_exp_f32 v10, v10
    v_exp_f32 v26, v26
    v_exp_f32 v11, v11
    v_exp_f32 v27, v27
    v_exp_f32 v12, v12
    v_exp_f32 v28, v28
    v_exp_f32 v13, v13
    v_exp_f32 v29, v29
    v_exp_f32 v14, v14
    v_exp_f32 v30, v30
    v_exp_f32 v15, v15
    v_exp_f32_e64 v31, v31
    v_pk_add_f32 v[66:67], v[0:1], v[2:3]
    v_pk_add_f32 v[68:69], v[8:9], v[10:11]
    v_pk_add_f32 v[72:73], v[16:17], v[18:19]
    v_pk_add_f32 v[74:75], v[24:25], v[26:27]
    v_pk_add_f32 v[66:67], v[66:67], v[4:5]
    s_add_u32 m0, s19, 32768
    s_add_u32 s8, s18, 100352
    s_waitcnt lgkmcnt(4)
    buffer_load_dwordx4 v139, s[52:55], s8 offen lds
    buffer_load_dwordx4 v125, s[52:55], s8 offen offset:1024 lds
    v_pk_add_f32 v[68:69], v[68:69], v[12:13]
    v_pk_add_f32 v[72:73], v[72:73], v[20:21]
    v_pk_add_f32 v[74:75], v[74:75], v[28:29]
    v_pk_add_f32 v[66:67], v[66:67], v[6:7]
    v_pk_add_f32 v[68:69], v[68:69], v[14:15]
    v_pk_add_f32 v[72:73], v[72:73], v[22:23]
    v_pk_add_f32 v[74:75], v[74:75], v[30:31]
    v_pk_add_f32 v[66:67], v[66:67], v[68:69]
    v_pk_add_f32 v[72:73], v[72:73], v[74:75]
    v_add_f32 v64, v66, v67
    v_add_f32 v70, v72, v73
    v_mov_b32 v65, v64
    v_mov_b32 v71, v70
    s_nop 0
    v_permlane32_swap_b32 v64, v65
    v_permlane32_swap_b32 v70, v71
    v_add_f32 v64, v64, v65
    v_add_f32 v70, v70, v71
    v_rcp_f32 v64, v64
    v_rcp_f32 v70, v70
    v_pk_mul_f32 v[0:1], v[0:1], v[64:65] op_sel_hi:[1,0]
    s_add_u32 m0, s19, 34816
    s_add_u32 s8, s18, 114688
    s_waitcnt lgkmcnt(0)
    buffer_load_dwordx4 v139, s[52:55], s8 offen lds
    buffer_load_dwordx4 v125, s[52:55], s8 offen offset:1024 lds
    s_nop 0
    v_pk_mul_f32 v[16:17], v[16:17], v[70:71] op_sel_hi:[1,0]
    v_pk_mul_f32 v[2:3], v[2:3], v[64:65] op_sel_hi:[1,0]
    v_pk_mul_f32 v[18:19], v[18:19], v[70:71] op_sel_hi:[1,0]
    v_pk_mul_f32 v[4:5], v[4:5], v[64:65] op_sel_hi:[1,0]
    v_pk_mul_f32 v[20:21], v[20:21], v[70:71] op_sel_hi:[1,0]
    v_pk_mul_f32 v[6:7], v[6:7], v[64:65] op_sel_hi:[1,0]
    v_pk_mul_f32 v[22:23], v[22:23], v[70:71] op_sel_hi:[1,0]
    v_pk_mul_f32 v[8:9], v[8:9], v[64:65] op_sel_hi:[1,0]
    v_pk_mul_f32 v[24:25], v[24:25], v[70:71] op_sel_hi:[1,0]
    v_pk_mul_f32 v[10:11], v[10:11], v[64:65] op_sel_hi:[1,0]
    v_pk_mul_f32 v[26:27], v[26:27], v[70:71] op_sel_hi:[1,0]
    v_pk_mul_f32 v[12:13], v[12:13], v[64:65] op_sel_hi:[1,0]
    v_pk_mul_f32 v[28:29], v[28:29], v[70:71] op_sel_hi:[1,0]
    v_pk_mul_f32 v[14:15], v[14:15], v[64:65] op_sel_hi:[1,0]
    v_pk_mul_f32 v[30:31], v[30:31], v[70:71] op_sel_hi:[1,0]
    v_cvt_pk_bf16_f32 v0, v0, v1
    v_cvt_pk_bf16_f32 v16, v16, v17
    v_cvt_pk_bf16_f32 v1, v2, v3
    v_cvt_pk_bf16_f32 v17, v18, v19
    v_cvt_pk_bf16_f32 v2, v4, v5
    v_cvt_pk_bf16_f32 v18, v20, v21
    v_cvt_pk_bf16_f32 v3, v6, v7
    v_cvt_pk_bf16_f32 v19, v22, v23
    v_cvt_pk_bf16_f32 v4, v8, v9
    v_cvt_pk_bf16_f32 v20, v24, v25
    v_cvt_pk_bf16_f32 v5, v10, v11
    v_cvt_pk_bf16_f32 v21, v26, v27
    v_cvt_pk_bf16_f32 v6, v12, v13
    v_cvt_pk_bf16_f32 v22, v28, v29
    v_cvt_pk_bf16_f32 v7, v14, v15
    v_cvt_pk_bf16_f32 v23, v30, v31
    ds_write_b128 v48, v[0:3] offset:0
    ds_write_b128 v49, v[4:7] offset:0
    ds_write_b128 v48, v[16:19] offset:16384
    ds_write_b128 v49, v[20:23] offset:16384
    s_waitcnt lgkmcnt(0)
    s_barrier
    v_mov_b32 v138, 0xff800000
    v_max3_f32 v64, -v32, -v33, -v34
    v_max3_f32 v65, -v40, -v41, -v42
    v_max3_f32 v64, v64, -v35, -v36
    v_max3_f32 v65, v65, -v43, -v44
    v_max3_f32 v64, v64, -v37, -v38
    v_max3_f32 v65, v65, -v45, -v46
    v_max3_f32 v65, v65, -v39, -v47
    v_max_f32 v64, v64, v65
    v_mov_b32 v65, v64
    s_nop 1
    v_permlane32_swap_b32 v64, v65
    v_max_f32_e64 v64, v64, v65
    v_mul_f32 v64, -v104, v64
    v_cndmask_b32 v65, v64, v138, s[28:29]
    v_pk_fma_f32 v[32:33], v[32:33], v[104:105], v[64:65] op_sel_hi:[1,0,0] neg_lo:[1,0,0] neg_hi:[1,0,0]
    v_pk_fma_f32 v[34:35], v[34:35], v[104:105], v[64:65] op_sel_hi:[1,0,0] neg_lo:[1,0,0] neg_hi:[1,0,0]
    v_pk_fma_f32 v[36:37], v[36:37], v[104:105], v[64:65] op_sel_hi:[1,0,0] neg_lo:[1,0,0] neg_hi:[1,0,0]
    v_pk_fma_f32 v[38:39], v[38:39], v[104:105], v[64:65] op_sel_hi:[1,0,0] neg_lo:[1,0,0] neg_hi:[1,0,0]
    v_pk_fma_f32 v[40:41], v[40:41], v[104:105], v[64:65] op_sel_hi:[1,0,0] neg_lo:[1,0,0] neg_hi:[1,0,0]
    v_pk_fma_f32 v[42:43], v[42:43], v[104:105], v[64:65] op_sel_hi:[1,0,0] neg_lo:[1,0,0] neg_hi:[1,0,0]
    v_pk_fma_f32 v[44:45], v[44:45], v[104:105], v[64:65] op_sel:[0,0,1] op_sel_hi:[1,0,1] neg_lo:[1,0,0] neg_hi:[1,0,0]
    v_pk_fma_f32 v[46:47], v[46:47], v[104:105], v[64:65] op_sel:[0,0,1] op_sel_hi:[1,0,1] neg_lo:[1,0,0] neg_hi:[1,0,0]
    v_exp_f32 v32, v32
    v_exp_f32 v33, v33
    v_exp_f32 v34, v34
    v_exp_f32 v35, v35
    v_exp_f32 v36, v36
    v_exp_f32 v37, v37
    v_exp_f32 v38, v38
    v_exp_f32 v39, v39
    v_exp_f32 v40, v40
    v_exp_f32 v41, v41
    v_exp_f32 v42, v42
    v_exp_f32 v43, v43
    v_exp_f32 v44, v44
    v_exp_f32 v45, v45
    v_exp_f32 v46, v46
    v_exp_f32 v47, v47
    v_pk_add_f32 v[66:67], v[32:33], v[34:35]
    v_pk_add_f32 v[68:69], v[40:41], v[42:43]
    v_pk_add_f32 v[66:67], v[66:67], v[36:37]
    v_pk_add_f32 v[68:69], v[68:69], v[44:45]
    v_pk_add_f32 v[66:67], v[66:67], v[38:39]
    v_pk_add_f32 v[68:69], v[68:69], v[46:47]
    v_pk_add_f32 v[66:67], v[66:67], v[68:69]
    v_add_f32 v64, v66, v67
    v_mov_b32 v65, v64
    s_nop 1
    v_permlane32_swap_b32 v64, v65
    v_add_f32 v64, v64, v65
    v_rcp_f32_e64 v64, v64
    s_nop 0
    v_pk_mul_f32 v[32:33], v[32:33], v[64:65] op_sel_hi:[1,0]
    v_pk_mul_f32 v[34:35], v[34:35], v[64:65] op_sel_hi:[1,0]
    v_pk_mul_f32 v[36:37], v[36:37], v[64:65] op_sel_hi:[1,0]
    v_pk_mul_f32 v[38:39], v[38:39], v[64:65] op_sel_hi:[1,0]
    v_pk_mul_f32 v[40:41], v[40:41], v[64:65] op_sel_hi:[1,0]
    v_pk_mul_f32 v[42:43], v[42:43], v[64:65] op_sel_hi:[1,0]
    v_pk_mul_f32 v[44:45], v[44:45], v[64:65] op_sel_hi:[1,0]
    v_pk_mul_f32 v[46:47], v[46:47], v[64:65] op_sel_hi:[1,0]
    v_cvt_pk_bf16_f32 v32, v32, v33
    v_cvt_pk_bf16_f32 v33, v34, v35
    v_cvt_pk_bf16_f32 v34, v36, v37
    v_cvt_pk_bf16_f32 v35, v38, v39
    v_cvt_pk_bf16_f32 v36, v40, v41
    v_cvt_pk_bf16_f32 v37, v42, v43
    v_cvt_pk_bf16_f32 v38, v44, v45
    v_cvt_pk_bf16_f32 v39, v46, v47
    ds_write_b128 v48, v[32:35] offset:32768
    ds_write_b128 v49, v[36:39] offset:32768
    s_waitcnt lgkmcnt(0)
    s_barrier
    s_cmp_eq_u32 s23, 0
    s_cbranch_scc1 L_nounitv
    s_setprio 3
    ds_read_b64_tr_b16 v[80:81], v51 offset:0
    ds_read_b64_tr_b16 v[84:85], v52 offset:0
    ds_read_b64_tr_b16 v[82:83], v51 offset:512
    ds_read_b64_tr_b16 v[86:87], v52 offset:512
    ds_read_b64_tr_b16 v[88:89], v51 offset:1024
    ds_read_b64_tr_b16 v[92:93], v52 offset:1024
    ds_read_b64_tr_b16 v[90:91], v51 offset:1536
    ds_read_b64_tr_b16 v[94:95], v52 offset:1536
    ds_read_b64_tr_b16 v[96:97], v51 offset:2048
    ds_read_b64_tr_b16 v[100:101], v52 offset:2048
    ds_read_b64_tr_b16 v[98:99], v51 offset:2560
    ds_read_b64_tr_b16 v[102:103], v52 offset:2560
    ds_read_b64_tr_b16 v[112:113], v51 offset:3072
    ds_read_b64_tr_b16 v[116:117], v52 offset:3072
    ds_read_b64_tr_b16 v[114:115], v51 offset:3584
    ds_read_b64_tr_b16 v[118:119], v52 offset:3584
    s_waitcnt lgkmcnt(12)
    v_mfma_f32_32x32x16_bf16 v[0:15], v[80:83], v[84:87], 0
    ds_read_b64_tr_b16 v[80:81], v51 offset:4096
    ds_read_b64_tr_b16 v[84:85], v52 offset:4096
    ds_read_b64_tr_b16 v[82:83], v51 offset:4608
    ds_read_b64_tr_b16 v[86:87], v52 offset:4608
    s_waitcnt lgkmcnt(12)
    v_mfma_f32_32x32x16_bf16 v[0:15], v[88:91], v[92:95], v[0:15]
    ds_read_b64_tr_b16 v[88:89], v51 offset:5120
    ds_read_b64_tr_b16 v[92:93], v52 offset:5120
    ds_read_b64_tr_b16 v[90:91], v51 offset:5632
    ds_read_b64_tr_b16 v[94:95], v52 offset:5632
    s_waitcnt lgkmcnt(12)
    v_mfma_f32_32x32x16_bf16 v[0:15], v[96:99], v[100:103], v[0:15]
    ds_read_b64_tr_b16 v[96:97], v51 offset:6144
    ds_read_b64_tr_b16 v[100:101], v52 offset:6144
    ds_read_b64_tr_b16 v[98:99], v51 offset:6656
    ds_read_b64_tr_b16 v[102:103], v52 offset:6656
    s_waitcnt lgkmcnt(12)
    v_mfma_f32_32x32x16_bf16 v[0:15], v[112:115], v[116:119], v[0:15]
    ds_read_b64_tr_b16 v[112:113], v51 offset:7168
    ds_read_b64_tr_b16 v[116:117], v52 offset:7168
    ds_read_b64_tr_b16 v[114:115], v51 offset:7680
    ds_read_b64_tr_b16 v[118:119], v52 offset:7680
    s_waitcnt lgkmcnt(12)
    v_mfma_f32_32x32x16_bf16 v[0:15], v[80:83], v[84:87], v[0:15]
    s_waitcnt lgkmcnt(8)
    v_mfma_f32_32x32x16_bf16 v[0:15], v[88:91], v[92:95], v[0:15]
    s_waitcnt lgkmcnt(4)
    v_mfma_f32_32x32x16_bf16 v[0:15], v[96:99], v[100:103], v[0:15]
    s_waitcnt lgkmcnt(0)
    v_mfma_f32_32x32x16_bf16 v[0:15], v[112:115], v[116:119], v[0:15]
    s_nop 7
    s_nop 4
    buffer_atomic_add_f32 v0, v53, s[64:67], s0 offen offset:0
    buffer_atomic_add_f32 v1, v53, s[64:67], s0 offen offset:256
    buffer_atomic_add_f32 v2, v53, s[64:67], s0 offen offset:512
    buffer_atomic_add_f32 v3, v53, s[64:67], s0 offen offset:768
    buffer_atomic_add_f32 v4, v53, s[64:67], s0 offen offset:2048
    buffer_atomic_add_f32 v5, v53, s[64:67], s0 offen offset:2304
    buffer_atomic_add_f32 v6, v53, s[64:67], s0 offen offset:2560
    buffer_atomic_add_f32 v7, v53, s[64:67], s0 offen offset:2816
    buffer_atomic_add_f32 v8, v53, s[64:67], s10 offen offset:0
    buffer_atomic_add_f32 v9, v53, s[64:67], s10 offen offset:256
    buffer_atomic_add_f32 v10, v53, s[64:67], s10 offen offset:512
    buffer_atomic_add_f32 v11, v53, s[64:67], s10 offen offset:768
    buffer_atomic_add_f32 v12, v53, s[64:67], s10 offen offset:2048
    buffer_atomic_add_f32 v13, v53, s[64:67], s10 offen offset:2304
    s_mov_b32 exec_hi, 0
    buffer_atomic_add_f32 v14, v53, s[64:67], s10 offen offset:2560
    buffer_atomic_add_f32 v15, v53, s[64:67], s10 offen offset:2816
    s_mov_b64 exec, -1
L_nounitv:
    s_waitcnt vmcnt(0)
    s_barrier
    s_cmp_lg_u32 s4, 7
    s_cbranch_scc1 L_nokfv
    v_mov_b32 v96, s35
    v_mov_b32 v97, 0
    s_mov_b64 exec, 1
    buffer_store_dword v96, v97, s[64:67], s1 offen sc1
    s_mov_b64 exec, -1
L_nokfv:
    s_setprio 0
    ds_read_b64_tr_b16 a[40:41], v142 offset:0
    ds_read_b64_tr_b16 a[42:43], v142 offset:1024
    ds_read_b64_tr_b16 a[44:45], v143 offset:0
    ds_read_b64_tr_b16 a[46:47], v143 offset:1024
    ds_read_b64_tr_b16 a[48:49], v142 offset:2048
    ds_read_b64_tr_b16 a[50:51], v142 offset:3072
    ds_read_b64_tr_b16 a[52:53], v143 offset:2048
    ds_read_b64_tr_b16 a[54:55], v143 offset:3072
    ds_read_b64_tr_b16 a[56:57], v142 offset:32768
    ds_read_b64_tr_b16 a[58:59], v142 offset:33792
    ds_read_b64_tr_b16 a[60:61], v143 offset:32768
    ds_read_b64_tr_b16 a[62:63], v143 offset:33792
    ds_read_b64_tr_b16 a[64:65], v142 offset:34816
    ds_read_b64_tr_b16 a[66:67], v142 offset:35840
    ds_read_b64_tr_b16 a[68:69], v143 offset:34816
    ds_read_b64_tr_b16 a[70:71], v143 offset:35840
    s_mov_b32 m0, s25
    s_add_u32 s8, s18, 57344
    buffer_load_dwordx4 v139, s[52:55], s8 offen lds
    buffer_load_dwordx4 v125, s[52:55], s8 offen offset:1024 lds
    s_add_u32 m0, s19, 0
    s_add_u32 s8, s18, 143360
    s_waitcnt lgkmcnt(12)
    buffer_load_dwordx4 v139, s[52:55], s8 offen lds
    buffer_load_dwordx4 v125, s[52:55], s8 offen offset:1024 lds
    s_add_u32 m0, s19, 2048
    s_add_u32 s8, s18, 157696
    s_waitcnt lgkmcnt(8)
    buffer_load_dwordx4 v139, s[52:55], s8 offen lds
    buffer_load_dwordx4 v125, s[52:55], s8 offen offset:1024 lds
    v_accvgpr_read_b32 v129, a72
    v_accvgpr_read_b32 v130, a73
    v_accvgpr_read_b32 v131, a74
    v_accvgpr_read_b32 v136, a75
    v_accvgpr_read_b32 v137, a76
    v_accvgpr_read_b32 v138, a77
    buffer_load_dword v128, v129, s[64:67], s98 offen sc1
    s_add_u32 m0, s19, 32768
    s_add_u32 s8, s18, 172032
    s_waitcnt lgkmcnt(4)
    buffer_load_dwordx4 v139, s[52:55], s8 offen lds
    buffer_load_dwordx4 v125, s[52:55], s8 offen offset:1024 lds
    s_add_u32 m0, s19, 34816
    s_add_u32 s8, s18, 186368
    s_waitcnt lgkmcnt(0)
    buffer_load_dwordx4 v139, s[52:55], s8 offen lds
    buffer_load_dwordx4 v125, s[52:55], s8 offen offset:1024 lds
    s_waitcnt vmcnt(9)
    ds_read_b64_tr_b16 a[32:33], v126 offset:0
    ds_read_b64_tr_b16 a[34:35], v126 offset:1024
    ds_read_b64_tr_b16 a[36:37], v127 offset:0
    ds_read_b64_tr_b16 a[38:39], v127 offset:1024
    s_mov_b32 m0, s25
    s_add_u32 s8, s18, 129024
    s_waitcnt lgkmcnt(0)
    buffer_load_dwordx4 v139, s[52:55], s8 offen lds
    buffer_load_dwordx4 v125, s[52:55], s8 offen offset:1024 lds
    s_waitcnt lgkmcnt(0)
    s_waitcnt vmcnt(6)
    s_nop 0
    s_branch L_p2
    s_nop 0
L_ffn:
    s_mov_b32 s40, s26
    s_and_b32 s41, s27, 0xffff
    s_mov_b32 s42, 1605632
    s_mov_b32 s43, 0x20000
    v_mul_u32_u24 v6, 3584, v6
    v_lshl_add_u32 v124, v7, 4, v6
    s_mul_i32 s13, s5, 448
    v_add_u32 v125, 6272, v124
    v_add_u32 v126, 12544, v124
    v_add_u32 v127, 18816, v124
    s_mul_i32 s8, s4, 28672
    s_add_u32 s13, s13, s8
    s_add_u32 m0, s32, 0
    s_mov_b64 exec, s[14:15]
    buffer_load_dwordx4 v124, s[40:43], s13 offen offset:0 lds
    buffer_load_dwordx4 v125, s[40:43], s13 offen offset:896 lds
    s_mov_b64 exec, -1
    s_mov_b64 exec, s[14:15]
    buffer_load_dwordx4 v126, s[40:43], s13 offen offset:1792 lds
    buffer_load_dwordx4 v127, s[40:43], s13 offen offset:2688 lds
    s_mov_b64 exec, -1
    s_add_u32 m0, s33, 0
    s_add_u32 s13, s13, 229376
    buffer_load_dwordx4 v122, s[36:39], s12 offen offset:0 lds
    buffer_load_dwordx4 v123, s[36:39], s12 offen offset:1024 lds
    s_add_u32 s12, s12, 128
    s_mul_i32 s8, s34, 896
    buffer_load_dwordx4 v[96:99], v5, s[36:39], s8 offen
    s_or_b32 s8, s2, s4
    s_cmp_lg_u32 s8, 0
    s_cbranch_scc1 L_nononf
    s_memrealtime s[8:9]
    s_waitcnt lgkmcnt(0)
    s_or_b32 s8, s8, 1
    v_mov_b32 v8, s8
    v_mov_b32 v9, 0
    s_mov_b64 exec, 1
    buffer_store_dword v8, v9, s[60:63], 0 offen sc1
    s_mov_b64 exec, -1
L_nononf:
    s_mul_i32 s10, s69, 192
    s_add_u32 s10, s10, 16384
    v_and_b32 v128, 31, v0
    v_lshlrev_b32 v128, 7, v128
    s_lshl_b32 s8, s68, 12
    v_add_u32 v128, s8, v128
    v_lshrrev_b32 v129, 5, v0
    v_bfe_u32 v130, v0, 1, 3
    v_xor_b32 v130, v130, v129
    v_lshlrev_b32 v131, 3, v129
    v_bfe_u32 v132, v0, 2, 2
    v_add_u32 v131, v131, v132
    v_mul_u32_u24 v131, 448, v131
    v_bfe_u32 v132, v0, 4, 1
    v_and_b32 v133, 3, v0
    v_lshl_add_u32 v132, v132, 2, v133
    s_lshl_b32 s8, s69, 2
    v_xor_b32 v134, s8, v132
    v_lshl_add_u32 v134, v134, 3, v131
    v_add_u32 v134, 16768, v134
    v_lshl_add_u32 v131, v132, 3, v131
    v_add_u32 v131, s10, v131
    s_add_u32 s8, s68, s69
    s_add_u32 s8, s8, 0
    s_and_b32 s8, s8, 3
    s_lshl_b32 s9, s8, 1
    v_xor_b32 v133, s9, v130
    v_lshl_add_u32 v112, v133, 4, v128
    s_mul_i32 s9, s8, 7168
    v_add_u32 v116, s9, v131
    v_add_u32 v120, s9, v134
    s_add_u32 s8, s68, s69
    s_add_u32 s8, s8, 1
    s_and_b32 s8, s8, 3
    s_lshl_b32 s9, s8, 1
    v_xor_b32 v133, s9, v130
    v_lshl_add_u32 v113, v133, 4, v128
    s_mul_i32 s9, s8, 7168
    v_add_u32 v117, s9, v131
    s_add_u32 s8, s68, s69
    s_add_u32 s8, s8, 2
    s_and_b32 s8, s8, 3
    s_lshl_b32 s9, s8, 1
    v_xor_b32 v133, s9, v130
    v_lshl_add_u32 v114, v133, 4, v128
    s_mul_i32 s9, s8, 7168
    v_add_u32 v118, s9, v131
    v_add_u32 v121, s9, v134
    s_add_u32 s8, s68, s69
    s_add_u32 s8, s8, 3
    s_and_b32 s8, s8, 3
    s_lshl_b32 s9, s8, 1
    v_xor_b32 v133, s9, v130
    v_lshl_add_u32 v115, v133, 4, v128
    s_mul_i32 s9, s8, 7168
    v_add_u32 v119, s9, v131
    s_mov_b32 s44, s20
    s_and_b32 s45, s21, 0xffff
    s_mov_b32 s46, 25088
    s_mov_b32 s47, 0x20000
    s_mov_b32 s48, s22
    s_and_b32 s49, s23, 0xffff
    s_mov_b32 s50, 401408
    s_mov_b32 s51, 0x20000
    s_mov_b32 s52, s28
    s_and_b32 s53, s29, 0xffff
    s_mov_b32 s54, 1605632
    s_mov_b32 s55, 0x20000
    s_mov_b32 s56, s30
    s_and_b32 s57, s31, 0xffff
    s_mov_b32 s58, 1835008
    s_mov_b32 s59, 0x20000
    s_mov_b32 s26, 0x3fb8aa3b
    s_mov_b32 s27, 0x3fb8aa3b
    s_mov_b32 s28, 0
    s_mov_b32 s29, -1
    s_mov_b32 s31, 0
    s_lshr_b32 s9, s2, 3
    s_and_b32 s8, s9, 3
    s_add_u32 s8, s8, 24
    s_cmp_lt_u32 s9, 24
    s_cselect_b32 s9, s9, s8
    s_mul_i32 s8, s9, 37
    s_lshr_b32 s8, s8, 8
    s_mul_i32 s10, s8, 7
    s_sub_u32 s17, s9, s10
    s_and_b32 s10, s2, 7
    s_lshl_b32 s10, s10, 2
    s_add_u32 s16, s10, s8
    s_mul_i32 s18, s4, 200704
    s_lshl_b32 s8, s17, 7
    s_add_u32 s18, s18, s8
    s_lshl_b32 s19, s4, 12
    s_add_u32 s19, s19, 57344
    v_lshrrev_b32 v64, 3, v140
    v_mul_u32_u24 v64, 896, v64
    v_lshrrev_b32 v65, 2, v140
    v_and_b32 v65, 4, v65
    v_and_b32 v66, 7, v140
    v_xor_b32 v65, v65, v66
    v_lshl_add_u32 v139, v65, 4, v64
    v_lshrrev_b32 v64, 5, v140
    v_lshlrev_b32 v64, 2, v64
    v_bfe_u32 v65, v140, 2, 2
    v_add_u32 v64, v64, v65
    v_lshlrev_b32 v64, 7, v64
    v_add_u32 v64, s19, v64
    v_and_b32 v65, 3, v140
    v_lshlrev_b32 v65, 3, v65
    v_and_b32 v66, 16, v140
    v_lshl_add_u32 v65, v66, 1, v65
    v_and_b32 v66, 8, v140
    v_lshlrev_b32 v66, 3, v66
    v_xor_b32 v65, v65, v66
    v_add_u32 v142, v64, v65
    v_xor_b32 v65, 64, v65
    v_add_u32 v143, v64, v65
    s_lshl_b32 s8, s16, 1
    s_mul_i32 s20, s8, 112
    s_mul_i32 s9, s4, 14
    s_add_u32 s20, s20, s9
    s_lshl_b32 s20, s20, 10
    s_add_u32 s21, s20, 114688
    s_bfe_u32 s9, s4, 0x10001
    s_add_u32 s10, s8, s9
    s_mul_i32 s22, s10, 28
    s_mul_i32 s9, s69, 14
    s_add_u32 s22, s22, s9
    s_lshl_b32 s10, s10, 1
    s_add_u32 s10, s10, s69
    s_lshl_b32 s10, s10, 8
    s_add_u32 s99, s10, 11829248
    s_lshl_b32 s22, s22, 10
    s_add_u32 s22, s22, 8388608
    v_lshrrev_b32 v64, 3, v140
    v_mul_u32_u24 v64, 896, v64
    v_and_b32 v65, 7, v140
    v_lshl_add_u32 v64, v65, 4, v64
    v_and_b32 v65, 1, v65
    v_lshlrev_b32 v65, 7, v65
    v_accvgpr_write_b32 a73, v64
    v_accvgpr_write_b32 a74, v65
    s_lshl_b32 s9, s16, 3
    s_add_u32 s9, s9, s4
    s_mul_i32 s9, s9, 7168
    s_lshl_b32 s8, s17, 7
    s_add_u32 s100, s9, s8
    s_lshl_b32 s8, s16, 12
    s_lshl_b32 s9, s4, 8
    s_add_u32 s9, s9, s8
    s_add_u32 s98, s9, 11534336
    v_and_b32 v64, 1, v140
    v_lshlrev_b32 v64, 11, v64
    v_and_b32 v65, 2, v140
    v_lshl_add_u32 v64, v65, 6, v64
    v_accvgpr_write_b32 a72, v64
    v_lshrrev_b32 v66, 5, v140
    v_bfe_u32 v64, v140, 3, 1
    v_xor_b32 v64, v64, v66
    v_mul_u32_u24 v65, 14, v66
    v_bfe_u32 v66, v140, 2, 2
    v_add_u32 v65, v65, v66
    v_lshlrev_b32 v65, 7, v65
    v_lshl_add_u32 v64, v64, 6, v65
    v_and_b32 v65, 3, v140
    v_lshl_add_u32 v64, v65, 3, v64
    v_and_b32 v65, 16, v140
    v_lshl_add_u32 v64, v65, 1, v64
    s_and_b32 s9, s4, 1
    s_lshl_b32 s9, s9, 6
    v_xor_b32 v64, s9, v64
    s_mul_i32 s9, s69, 28672
    v_add_u32 v64, s9, v64
    v_xor_b32 v65, 64, v64
    v_accvgpr_write_b32 a75, v64
    v_accvgpr_write_b32 a76, v65
    v_add_u32 v65, 1792, v65
    v_and_b32 v66, 8, v140
    v_cmp_eq_u32 vcc, 0, v66
    s_nop 1
    v_cndmask_b32 v65, v65, v64, vcc
    v_accvgpr_write_b32 a77, v65
    v_and_b32 v64, 31, v140
    v_mov_b32 v66, 0x7f000000
    s_lshl_b32 s8, s69, 4
    v_xor_b32 v65, s8, v64
    v_lshlrev_b32 v65, 4, v65
    s_mul_i32 s8, s69, 1536
    s_sub_u32 s8, 3072, s8
    v_add_u32 v65, s8, v65
    v_cndmask_b32 v109, v65, v66, s[28:29]
    v_lshlrev_b32 v64, 4, v64
    v_cndmask_b32 v108, v64, v66, s[28:29]
    v_and_b32 v64, 31, v140
    v_lshlrev_b32 v110, 7, v64
    s_mul_i32 s8, s5, 224
    s_mul_i32 s9, s69, 96
    s_add_u32 s8, s8, s9
    s_lshl_b32 s8, s8, 4
    s_add_u32 s30, s8, 12058624
    s_barrier
    s_add_u32 m0, s32, 45056
    s_mov_b64 exec, s[14:15]
    buffer_load_dwordx4 v124, s[40:43], s13 offen offset:0 lds
    buffer_load_dwordx4 v125, s[40:43], s13 offen offset:896 lds
    s_mov_b64 exec, -1
    s_mov_b64 exec, s[14:15]
    buffer_load_dwordx4 v126, s[40:43], s13 offen offset:1792 lds
    buffer_load_dwordx4 v127, s[40:43], s13 offen offset:2688 lds
    s_mov_b64 exec, -1
    s_add_u32 m0, s33, 45056
    s_add_u32 s13, s13, 229376
    buffer_load_dwordx4 v122, s[36:39], s12 offen offset:0 lds
    buffer_load_dwordx4 v123, s[36:39], s12 offen offset:1024 lds
    s_add_u32 s12, s12, 128
    s_mov_b32 s8, 0x3f803f80
    s_waitcnt vmcnt(6)
    v_dot2_f32_bf16 v104, v96, s8, 0
    v_dot2_f32_bf16 v105, v96, v96, 0
    v_dot2_f32_bf16 v104, v97, s8, v104
    v_dot2_f32_bf16 v105, v97, v97, v105
    v_dot2_f32_bf16 v104, v98, s8, v104
    v_dot2_f32_bf16 v105, v98, v98, v105
    v_dot2_f32_bf16 v104, v99, s8, v104
    v_dot2_f32_bf16 v105, v99, v99, v105
    s_nop 1
    v_add_f32_dpp v104, v104, v104 row_shr:1 row_mask:0xf bank_mask:0xf bound_ctrl:0
    v_add_f32_dpp v105, v105, v105 row_shr:1 row_mask:0xf bank_mask:0xf bound_ctrl:0
    s_nop 0
    v_add_f32_dpp v104, v104, v104 row_shr:2 row_mask:0xf bank_mask:0xf bound_ctrl:0
    v_add_f32_dpp v105, v105, v105 row_shr:2 row_mask:0xf bank_mask:0xf bound_ctrl:0
    s_nop 0
    v_add_f32_dpp v104, v104, v104 row_shr:4 row_mask:0xf bank_mask:0xf bound_ctrl:0
    v_add_f32_dpp v105, v105, v105 row_shr:4 row_mask:0xf bank_mask:0xf bound_ctrl:0
    s_nop 0
    v_add_f32_dpp v104, v104, v104 row_shr:8 row_mask:0xf bank_mask:0xf bound_ctrl:0
    v_add_f32_dpp v105, v105, v105 row_shr:8 row_mask:0xf bank_mask:0xf bound_ctrl:0
    s_nop 0
    v_add_f32_dpp v104, v104, v104 row_bcast:15 row_mask:0xa bank_mask:0xf
    v_add_f32_dpp v105, v105, v105 row_bcast:15 row_mask:0xa bank_mask:0xf
    s_nop 0
    v_add_f32_dpp v104, v104, v104 row_bcast:31 row_mask:0xc bank_mask:0xf
    v_add_f32_dpp v105, v105, v105 row_bcast:31 row_mask:0xc bank_mask:0xf
    v_mul_f32 v104, 0x3b124925, v104
    v_mul_f32 v105, 0x3b124925, v105
    v_fma_f32 v105, -v104, v104, v105
    v_max_f32 v105, 0, v105
    v_cvt_pk_bf16_f32 v104, v104, v104
    v_lshlrev_b32 v104, 16, v104
    v_cvt_pk_bf16_f32 v105, v105, v105
    v_lshlrev_b32 v105, 16, v105
    v_add_f32 v105, 0x3727c5ac, v105
    v_cvt_pk_bf16_f32 v105, v105, v105
    v_lshlrev_b32 v105, 16, v105
    v_sqrt_f32 v105, v105
    s_nop 0
    v_cvt_pk_bf16_f32 v105, v105, v105
    v_lshlrev_b32 v105, 16, v105
    v_rcp_f32 v105, v105
    v_sub_f32 v104, 0, v104
    s_barrier
    ds_read_b128 v[96:99], v112
    ds_read_b64_tr_b16 v[64:65], v120 offset:0
    ds_read_b64_tr_b16 v[66:67], v120 offset:1792
    ds_read_b64_tr_b16 v[68:69], v116 offset:0
    ds_read_b64_tr_b16 v[70:71], v116 offset:1792
    ds_read_b64_tr_b16 v[72:73], v116 offset:64
    ds_read_b64_tr_b16 v[74:75], v116 offset:1856
    ds_read_b64_tr_b16 v[76:77], v116 offset:128
    ds_read_b64_tr_b16 v[78:79], v116 offset:1920
    s_waitcnt lgkmcnt(4)
    v_mfma_f32_32x32x16_bf16 v[48:63], v[64:67], v[96:99], 0
    ds_read_b64_tr_b16 v[80:81], v117 offset:0
    ds_read_b64_tr_b16 v[82:83], v117 offset:1792
    ds_read_b128 v[100:103], v113
    s_add_u32 m0, s32, 90112
    s_mov_b64 exec, s[14:15]
    buffer_load_dwordx4 v124, s[40:43], s13 offen offset:0 lds
    buffer_load_dwordx4 v125, s[40:43], s13 offen offset:896 lds
    s_mov_b64 exec, -1
    v_mfma_f32_32x32x16_bf16 v[0:15], v[68:71], v[96:99], 0
    ds_read_b64_tr_b16 v[84:85], v117 offset:64
    ds_read_b64_tr_b16 v[86:87], v117 offset:1856
    s_waitcnt lgkmcnt(5)
    v_mfma_f32_32x32x16_bf16 v[16:31], v[72:75], v[96:99], 0
    ds_read_b64_tr_b16 v[88:89], v117 offset:128
    ds_read_b64_tr_b16 v[90:91], v117 offset:1920
    v_mfma_f32_32x32x16_bf16 v[32:47], v[76:79], v[96:99], 0
    ds_read_b64_tr_b16 v[92:93], v118 offset:64
    ds_read_b64_tr_b16 v[94:95], v118 offset:1856
    s_mov_b64 exec, s[14:15]
    buffer_load_dwordx4 v126, s[40:43], s13 offen offset:1792 lds
    buffer_load_dwordx4 v127, s[40:43], s13 offen offset:2688 lds
    s_mov_b64 exec, -1
    s_waitcnt lgkmcnt(4)
    v_mfma_f32_32x32x16_bf16 v[0:15], v[80:83], v[100:103], v[0:15]
    ds_read_b64_tr_b16 v[64:65], v118 offset:128
    ds_read_b64_tr_b16 v[66:67], v118 offset:1920
    ds_read_b128 v[96:99], v114
    v_mfma_f32_32x32x16_bf16 v[16:31], v[84:87], v[100:103], v[16:31]
    ds_read_b64_tr_b16 v[68:69], v118 offset:0
    ds_read_b64_tr_b16 v[70:71], v118 offset:1792
    s_waitcnt lgkmcnt(5)
    v_mfma_f32_32x32x16_bf16 v[32:47], v[88:91], v[100:103], v[32:47]
    ds_read_b64_tr_b16 v[72:73], v121 offset:0
    ds_read_b64_tr_b16 v[74:75], v121 offset:1792
    s_add_u32 m0, s33, 90112
    s_add_u32 s13, s13, 229376
    buffer_load_dwordx4 v122, s[36:39], s12 offen offset:0 lds
    buffer_load_dwordx4 v123, s[36:39], s12 offen offset:1024 lds
    s_add_u32 s12, s12, 128
    s_waitcnt lgkmcnt(4)
    v_mfma_f32_32x32x16_bf16 v[16:31], v[92:95], v[96:99], v[16:31]
    ds_read_b64_tr_b16 v[76:77], v119 offset:128
    ds_read_b64_tr_b16 v[78:79], v119 offset:1920
    ds_read_b128 v[100:103], v115
    s_waitcnt lgkmcnt(5)
    v_mfma_f32_32x32x16_bf16 v[32:47], v[64:67], v[96:99], v[32:47]
    ds_read_b64_tr_b16 v[80:81], v119 offset:0
    ds_read_b64_tr_b16 v[82:83], v119 offset:1792
    v_mfma_f32_32x32x16_bf16 v[0:15], v[68:71], v[96:99], v[0:15]
    ds_read_b64_tr_b16 v[84:85], v119 offset:64
    ds_read_b64_tr_b16 v[86:87], v119 offset:1856
    s_waitcnt lgkmcnt(5)
    v_mfma_f32_32x32x16_bf16 v[48:63], v[72:75], v[96:99], v[48:63]
    s_nop 0
    v_add_u32 v112, 45056, v112
    v_add_u32 v113, 45056, v113
    v_add_u32 v114, 45056, v114
    v_add_u32 v115, 45056, v115
    v_add_u32 v116, 45056, v116
    v_add_u32 v117, 45056, v117
    v_add_u32 v118, 45056, v118
    v_add_u32 v119, 45056, v119
    v_add_u32 v120, 45056, v120
    v_add_u32 v121, 45056, v121
    s_waitcnt lgkmcnt(0)
    s_waitcnt vmcnt(6)
    s_barrier
    ds_read_b64_tr_b16 v[88:89], v120 offset:0
    ds_read_b64_tr_b16 v[90:91], v120 offset:1792
    v_mov_b32 v107, 0
    buffer_load_dword v106, v107, s[60:63], 0 offen sc1
    v_mfma_f32_32x32x16_bf16 v[32:47], v[76:79], v[100:103], v[32:47]
    ds_read_b64_tr_b16 v[92:93], v116 offset:0
    ds_read_b64_tr_b16 v[94:95], v116 offset:1792
    ds_read_b128 v[96:99], v112
    v_mfma_f32_32x32x16_bf16 v[0:15], v[80:83], v[100:103], v[0:15]
    ds_read_b64_tr_b16 v[64:65], v116 offset:64
    ds_read_b64_tr_b16 v[66:67], v116 offset:1856
    s_add_u32 m0, s32, 0
    s_mov_b64 exec, s[14:15]
    buffer_load_dwordx4 v124, s[40:43], s13 offen offset:0 lds
    buffer_load_dwordx4 v125, s[40:43], s13 offen offset:896 lds
    s_mov_b64 exec, -1
    v_mfma_f32_32x32x16_bf16 v[16:31], v[84:87], v[100:103], v[16:31]
    ds_read_b64_tr_b16 v[68:69], v116 offset:128
    ds_read_b64_tr_b16 v[70:71], v116 offset:1920
    s_waitcnt lgkmcnt(4)
    v_mfma_f32_32x32x16_bf16 v[48:63], v[88:91], v[96:99], v[48:63]
    ds_read_b64_tr_b16 v[72:73], v117 offset:0
    ds_read_b64_tr_b16 v[74:75], v117 offset:1792
    ds_read_b128 v[100:103], v113
    v_mfma_f32_32x32x16_bf16 v[0:15], v[92:95], v[96:99], v[0:15]
    ds_read_b64_tr_b16 v[76:77], v117 offset:64
    ds_read_b64_tr_b16 v[78:79], v117 offset:1856
    s_mov_b64 exec, s[14:15]
    buffer_load_dwordx4 v126, s[40:43], s13 offen offset:1792 lds
    buffer_load_dwordx4 v127, s[40:43], s13 offen offset:2688 lds
    s_mov_b64 exec, -1
    s_waitcnt lgkmcnt(5)
    v_mfma_f32_32x32x16_bf16 v[16:31], v[64:67], v[96:99], v[16:31]
    ds_read_b64_tr_b16 v[80:81], v117 offset:128
    ds_read_b64_tr_b16 v[82:83], v117 offset:1920
    v_mfma_f32_32x32x16_bf16 v[32:47], v[68:71], v[96:99], v[32:47]
    ds_read_b64_tr_b16 v[84:85], v118 offset:64
    ds_read_b64_tr_b16 v[86:87], v118 offset:1856
    s_waitcnt lgkmcnt(4)
    v_mfma_f32_32x32x16_bf16 v[0:15], v[72:75], v[100:103], v[0:15]
    ds_read_b64_tr_b16 v[88:89], v118 offset:128
    ds_read_b64_tr_b16 v[90:91], v118 offset:1920
    ds_read_b128 v[96:99], v114
    s_add_u32 m0, s33, 0
    s_add_u32 s13, s13, 229376
    buffer_load_dwordx4 v122, s[36:39], s12 offen offset:0 lds
    buffer_load_dwordx4 v123, s[36:39], s12 offen offset:1024 lds
    s_add_u32 s12, s12, 128
    v_mfma_f32_32x32x16_bf16 v[16:31], v[76:79], v[100:103], v[16:31]
    ds_read_b64_tr_b16 v[92:93], v118 offset:0
    ds_read_b64_tr_b16 v[94:95], v118 offset:1792
    s_waitcnt lgkmcnt(5)
    v_mfma_f32_32x32x16_bf16 v[32:47], v[80:83], v[100:103], v[32:47]
    ds_read_b64_tr_b16 v[64:65], v121 offset:0
    ds_read_b64_tr_b16 v[66:67], v121 offset:1792
    s_waitcnt lgkmcnt(4)
    v_mfma_f32_32x32x16_bf16 v[16:31], v[84:87], v[96:99], v[16:31]
    ds_read_b64_tr_b16 v[68:69], v119 offset:128
    ds_read_b64_tr_b16 v[70:71], v119 offset:1920
    ds_read_b128 v[100:103], v115
    s_waitcnt lgkmcnt(5)
    v_mfma_f32_32x32x16_bf16 v[32:47], v[88:91], v[96:99], v[32:47]
    ds_read_b64_tr_b16 v[72:73], v119 offset:0
    ds_read_b64_tr_b16 v[74:75], v119 offset:1792
    v_mfma_f32_32x32x16_bf16 v[0:15], v[92:95], v[96:99], v[0:15]
    ds_read_b64_tr_b16 v[76:77], v119 offset:64
    ds_read_b64_tr_b16 v[78:79], v119 offset:1856
    s_waitcnt lgkmcnt(5)
    v_mfma_f32_32x32x16_bf16 v[48:63], v[64:67], v[96:99], v[48:63]
    s_nop 0
    v_add_u32 v112, 45056, v112
    v_add_u32 v113, 45056, v113
    v_add_u32 v114, 45056, v114
    v_add_u32 v115, 45056, v115
    v_add_u32 v116, 45056, v116
    v_add_u32 v117, 45056, v117
    v_add_u32 v118, 45056, v118
    v_add_u32 v119, 45056, v119
    v_add_u32 v120, 45056, v120
    v_add_u32 v121, 45056, v121
    s_waitcnt lgkmcnt(0)
    s_waitcnt vmcnt(7)
    s_barrier
    ds_read_b64_tr_b16 v[80:81], v120 offset:0
    ds_read_b64_tr_b16 v[82:83], v120 offset:1792
    s_add_u32 m0, s32, 45056
    s_mov_b64 exec, s[14:15]
    buffer_load_dwordx4 v124, s[40:43], s13 offen offset:0 lds
    buffer_load_dwordx4 v125, s[40:43], s13 offen offset:896 lds
    s_mov_b64 exec, -1
    v_mfma_f32_32x32x16_bf16 v[32:47], v[68:71], v[100:103], v[32:47]
    ds_read_b64_tr_b16 v[84:85], v116 offset:0
    ds_read_b64_tr_b16 v[86:87], v116 offset:1792
    ds_read_b128 v[96:99], v112
    v_mfma_f32_32x32x16_bf16 v[0:15], v[72:75], v[100:103], v[0:15]
    ds_read_b64_tr_b16 v[88:89], v116 offset:64
    ds_read_b64_tr_b16 v[90:91], v116 offset:1856
    v_mfma_f32_32x32x16_bf16 v[16:31], v[76:79], v[100:103], v[16:31]
    ds_read_b64_tr_b16 v[92:93], v116 offset:128
    ds_read_b64_tr_b16 v[94:95], v116 offset:1920
    s_mov_b64 exec, s[14:15]
    buffer_load_dwordx4 v126, s[40:43], s13 offen offset:1792 lds
    buffer_load_dwordx4 v127, s[40:43], s13 offen offset:2688 lds
    s_mov_b64 exec, -1
    s_waitcnt lgkmcnt(4)
    v_mfma_f32_32x32x16_bf16 v[48:63], v[80:83], v[96:99], v[48:63]
    ds_read_b64_tr_b16 v[64:65], v117 offset:0
    ds_read_b64_tr_b16 v[66:67], v117 offset:1792
    ds_read_b128 v[100:103], v113
    v_mfma_f32_32x32x16_bf16 v[0:15], v[84:87], v[96:99], v[0:15]
    ds_read_b64_tr_b16 v[68:69], v117 offset:64
    ds_read_b64_tr_b16 v[70:71], v117 offset:1856
    s_waitcnt lgkmcnt(5)
    v_mfma_f32_32x32x16_bf16 v[16:31], v[88:91], v[96:99], v[16:31]
    ds_read_b64_tr_b16 v[72:73], v117 offset:128
    ds_read_b64_tr_b16 v[74:75], v117 offset:1920
    s_add_u32 m0, s33, 45056
    s_add_u32 s13, s13, 229376
    buffer_load_dwordx4 v122, s[36:39], s12 offen offset:0 lds
    buffer_load_dwordx4 v123, s[36:39], s12 offen offset:1024 lds
    s_add_u32 s12, s12, 128
    v_mfma_f32_32x32x16_bf16 v[32:47], v[92:95], v[96:99], v[32:47]
    ds_read_b64_tr_b16 v[76:77], v118 offset:64
    ds_read_b64_tr_b16 v[78:79], v118 offset:1856
    s_waitcnt lgkmcnt(4)
    v_mfma_f32_32x32x16_bf16 v[0:15], v[64:67], v[100:103], v[0:15]
    ds_read_b64_tr_b16 v[80:81], v118 offset:128
    ds_read_b64_tr_b16 v[82:83], v118 offset:1920
    ds_read_b128 v[96:99], v114
    v_mfma_f32_32x32x16_bf16 v[16:31], v[68:71], v[100:103], v[16:31]
    ds_read_b64_tr_b16 v[84:85], v118 offset:0
    ds_read_b64_tr_b16 v[86:87], v118 offset:1792
    s_waitcnt lgkmcnt(5)
    v_mfma_f32_32x32x16_bf16 v[32:47], v[72:75], v[100:103], v[32:47]
    ds_read_b64_tr_b16 v[88:89], v121 offset:0
    ds_read_b64_tr_b16 v[90:91], v121 offset:1792
    s_waitcnt lgkmcnt(4)
    v_mfma_f32_32x32x16_bf16 v[16:31], v[76:79], v[96:99], v[16:31]
    ds_read_b64_tr_b16 v[92:93], v119 offset:128
    ds_read_b64_tr_b16 v[94:95], v119 offset:1920
    ds_read_b128 v[100:103], v115
    s_waitcnt lgkmcnt(5)
    v_mfma_f32_32x32x16_bf16 v[32:47], v[80:83], v[96:99], v[32:47]
    ds_read_b64_tr_b16 v[64:65], v119 offset:0
    ds_read_b64_tr_b16 v[66:67], v119 offset:1792
    v_mfma_f32_32x32x16_bf16 v[0:15], v[84:87], v[96:99], v[0:15]
    ds_read_b64_tr_b16 v[68:69], v119 offset:64
    ds_read_b64_tr_b16 v[70:71], v119 offset:1856
    s_waitcnt lgkmcnt(5)
    v_mfma_f32_32x32x16_bf16 v[48:63], v[88:91], v[96:99], v[48:63]
    v_subrev_u32 v112, 90112, v112
    v_subrev_u32 v113, 90112, v113
    v_subrev_u32 v114, 90112, v114
    v_subrev_u32 v115, 90112, v115
    v_subrev_u32 v116, 90112, v116
    v_subrev_u32 v117, 90112, v117
    v_subrev_u32 v118, 90112, v118
    v_subrev_u32 v119, 90112, v119
    v_subrev_u32 v120, 90112, v120
    v_subrev_u32 v121, 90112, v121
    s_waitcnt vmcnt(12)
    v_readfirstlane_b32 s35, v106
    s_nop 0
    s_cmp_lg_u32 s35, 0
    s_cbranch_scc1 L_gotnf
L_spinnf:
    buffer_load_dword v106, v107, s[60:63], 0 offen sc1
    s_waitcnt vmcnt(0)
    v_readfirstlane_b32 s35, v106
    s_nop 1
    s_cmp_lg_u32 s35, 0
    s_cbranch_scc1 L_gotnf
    s_nop 0
    s_add_u32 s31, s31, 1
    s_cmp_lt_u32 s31, 0x8000
    s_cbranch_scc1 L_spinnf
L_gotnf:
    v_mov_b32 v106, s35
    v_mov_b32 v107, s35
    s_lshl_b32 s8, s34, 4
    s_add_u32 s8, s8, 11927552
    v_mov_b32 v136, 0
    s_mov_b32 exec_lo, 0
    s_mov_b32 exec_hi, 0x80000000
    buffer_store_dwordx4 v[104:107], v136, s[64:67], s8 offen sc1
    s_mov_b64 exec, -1
    s_waitcnt lgkmcnt(0)
    s_waitcnt vmcnt(7)
    s_barrier
    ds_read_b64_tr_b16 v[72:73], v120 offset:0
    ds_read_b64_tr_b16 v[74:75], v120 offset:1792
    s_add_u32 m0, s32, 90112
    s_mov_b64 exec, s[14:15]
    buffer_load_dwordx4 v124, s[40:43], s13 offen offset:0 lds
    buffer_load_dwordx4 v125, s[40:43], s13 offen offset:896 lds
    s_mov_b64 exec, -1
    v_mfma_f32_32x32x16_bf16 v[32:47], v[92:95], v[100:103], v[32:47]
    ds_read_b64_tr_b16 v[76:77], v116 offset:0
    ds_read_b64_tr_b16 v[78:79], v116 offset:1792
    ds_read_b128 v[96:99], v112
    s_mov_b64 exec, s[14:15]
    buffer_load_dwordx4 v126, s[40:43], s13 offen offset:1792 lds
    buffer_load_dwordx4 v127, s[40:43], s13 offen offset:2688 lds
    s_mov_b64 exec, -1
    v_mfma_f32_32x32x16_bf16 v[0:15], v[64:67], v[100:103], v[0:15]
    ds_read_b64_tr_b16 v[80:81], v116 offset:64
    ds_read_b64_tr_b16 v[82:83], v116 offset:1856
    v_mfma_f32_32x32x16_bf16 v[16:31], v[68:71], v[100:103], v[16:31]
    ds_read_b64_tr_b16 v[84:85], v116 offset:128
    ds_read_b64_tr_b16 v[86:87], v116 offset:1920
    s_waitcnt lgkmcnt(4)
    v_mfma_f32_32x32x16_bf16 v[48:63], v[72:75], v[96:99], v[48:63]
    ds_read_b64_tr_b16 v[88:89], v117 offset:0
    ds_read_b64_tr_b16 v[90:91], v117 offset:1792
    ds_read_b128 v[100:103], v113
    s_add_u32 m0, s33, 90112
    s_add_u32 s13, s13, 229376
    buffer_load_dwordx4 v122, s[36:39], s12 offen offset:0 lds
    buffer_load_dwordx4 v123, s[36:39], s12 offen offset:1024 lds
    s_add_u32 s12, s12, 128
    v_mfma_f32_32x32x16_bf16 v[0:15], v[76:79], v[96:99], v[0:15]
    ds_read_b64_tr_b16 v[92:93], v117 offset:64
    ds_read_b64_tr_b16 v[94:95], v117 offset:1856
    s_waitcnt lgkmcnt(5)
    v_mfma_f32_32x32x16_bf16 v[16:31], v[80:83], v[96:99], v[16:31]
    ds_read_b64_tr_b16 v[64:65], v117 offset:128
    ds_read_b64_tr_b16 v[66:67], v117 offset:1920
    v_mfma_f32_32x32x16_bf16 v[32:47], v[84:87], v[96:99], v[32:47]
    ds_read_b64_tr_b16 v[68:69], v118 offset:64
    ds_read_b64_tr_b16 v[70:71], v118 offset:1856
    s_lshl_b32 s8, s2, 3
    s_add_u32 s8, s8, s4
    s_mul_i32 s9, s8, 896
    s_lshl_b32 s8, s8, 8
    v_lshlrev_b32 v132, 7, v140
    s_mov_b64 exec, 0x7f
    buffer_load_dword a80, v132, s[52:55], s9 offen
    s_mov_b64 exec, 3
    buffer_load_dword a80, v132, s[48:51], s8 offen
    s_mov_b64 exec, -1
    s_waitcnt lgkmcnt(4)
    v_mfma_f32_32x32x16_bf16 v[0:15], v[88:91], v[100:103], v[0:15]
    ds_read_b64_tr_b16 v[72:73], v118 offset:128
    ds_read_b64_tr_b16 v[74:75], v118 offset:1920
    ds_read_b128 v[96:99], v114
    v_mfma_f32_32x32x16_bf16 v[16:31], v[92:95], v[100:103], v[16:31]
    ds_read_b64_tr_b16 v[76:77], v118 offset:0
    ds_read_b64_tr_b16 v[78:79], v118 offset:1792
    s_waitcnt lgkmcnt(5)
    v_mfma_f32_32x32x16_bf16 v[32:47], v[64:67], v[100:103], v[32:47]
    ds_read_b64_tr_b16 v[80:81], v121 offset:0
    ds_read_b64_tr_b16 v[82:83], v121 offset:1792
    s_waitcnt lgkmcnt(4)
    v_mfma_f32_32x32x16_bf16 v[16:31], v[68:71], v[96:99], v[16:31]
    ds_read_b64_tr_b16 v[84:85], v119 offset:128
    ds_read_b64_tr_b16 v[86:87], v119 offset:1920
    ds_read_b128 v[100:103], v115
    s_waitcnt lgkmcnt(5)
    v_mfma_f32_32x32x16_bf16 v[32:47], v[72:75], v[96:99], v[32:47]
    ds_read_b64_tr_b16 v[88:89], v119 offset:0
    ds_read_b64_tr_b16 v[90:91], v119 offset:1792
    v_mfma_f32_32x32x16_bf16 v[0:15], v[76:79], v[96:99], v[0:15]
    ds_read_b64_tr_b16 v[92:93], v119 offset:64
    ds_read_b64_tr_b16 v[94:95], v119 offset:1856
    s_waitcnt lgkmcnt(5)
    v_mfma_f32_32x32x16_bf16 v[48:63], v[80:83], v[96:99], v[48:63]
    s_nop 0
    v_add_u32 v112, 45056, v112
    v_add_u32 v113, 45056, v113
    v_add_u32 v114, 45056, v114
    v_add_u32 v115, 45056, v115
    v_add_u32 v116, 45056, v116
    v_add_u32 v117, 45056, v117
    v_add_u32 v118, 45056, v118
    v_add_u32 v119, 45056, v119
    v_add_u32 v120, 45056, v120
    v_add_u32 v121, 45056, v121
    s_waitcnt lgkmcnt(0)
    s_waitcnt vmcnt(9)
    s_barrier
    ds_read_b64_tr_b16 v[64:65], v120 offset:0
    ds_read_b64_tr_b16 v[66:67], v120 offset:1792
    v_mfma_f32_32x32x16_bf16 v[32:47], v[84:87], v[100:103], v[32:47]
    ds_read_b64_tr_b16 v[68:69], v116 offset:0
    ds_read_b64_tr_b16 v[70:71], v116 offset:1792
    ds_read_b128 v[96:99], v112
    v_mfma_f32_32x32x16_bf16 v[0:15], v[88:91], v[100:103], v[0:15]
    ds_read_b64_tr_b16 v[72:73], v116 offset:64
    ds_read_b64_tr_b16 v[74:75], v116 offset:1856
    s_add_u32 m0, s32, 0
    s_mov_b64 exec, s[14:15]
    buffer_load_dwordx4 v124, s[40:43], s13 offen offset:0 lds
    buffer_load_dwordx4 v125, s[40:43], s13 offen offset:896 lds
    s_mov_b64 exec, -1
    v_mfma_f32_32x32x16_bf16 v[16:31], v[92:95], v[100:103], v[16:31]
    ds_read_b64_tr_b16 v[76:77], v116 offset:128
    ds_read_b64_tr_b16 v[78:79], v116 offset:1920
    s_waitcnt lgkmcnt(4)
    v_mfma_f32_32x32x16_bf16 v[48:63], v[64:67], v[96:99], v[48:63]
    ds_read_b64_tr_b16 v[80:81], v117 offset:0
    ds_read_b64_tr_b16 v[82:83], v117 offset:1792
    ds_read_b128 v[100:103], v113
    v_mfma_f32_32x32x16_bf16 v[0:15], v[68:71], v[96:99], v[0:15]
    ds_read_b64_tr_b16 v[84:85], v117 offset:64
    ds_read_b64_tr_b16 v[86:87], v117 offset:1856
    s_mov_b64 exec, s[14:15]
    buffer_load_dwordx4 v126, s[40:43], s13 offen offset:1792 lds
    buffer_load_dwordx4 v127, s[40:43], s13 offen offset:2688 lds
    s_mov_b64 exec, -1
    s_waitcnt lgkmcnt(5)
    v_mfma_f32_32x32x16_bf16 v[16:31], v[72:75], v[96:99], v[16:31]
    ds_read_b64_tr_b16 v[88:89], v117 offset:128
    ds_read_b64_tr_b16 v[90:91], v117 offset:1920
    v_mfma_f32_32x32x16_bf16 v[32:47], v[76:79], v[96:99], v[32:47]
    ds_read_b64_tr_b16 v[92:93], v118 offset:64
    ds_read_b64_tr_b16 v[94:95], v118 offset:1856
    s_waitcnt lgkmcnt(4)
    v_mfma_f32_32x32x16_bf16 v[0:15], v[80:83], v[100:103], v[0:15]
    ds_read_b64_tr_b16 v[64:65], v118 offset:128
    ds_read_b64_tr_b16 v[66:67], v118 offset:1920
    ds_read_b128 v[96:99], v114
    s_add_u32 m0, s33, 0
    s_add_u32 s13, s13, 229376
    buffer_load_dwordx4 v122, s[36:39], s12 offen offset:0 lds
    buffer_load_dwordx4 v123, s[36:39], s12 offen offset:1024 lds
    s_add_u32 s12, s12, 128
    v_mfma_f32_32x32x16_bf16 v[16:31], v[84:87], v[100:103], v[16:31]
    ds_read_b64_tr_b16 v[68:69], v118 offset:0
    ds_read_b64_tr_b16 v[70:71], v118 offset:1792
    s_waitcnt lgkmcnt(5)
    v_mfma_f32_32x32x16_bf16 v[32:47], v[88:91], v[100:103], v[32:47]
    ds_read_b64_tr_b16 v[72:73], v121 offset:0
    ds_read_b64_tr_b16 v[74:75], v121 offset:1792
    s_waitcnt lgkmcnt(4)
    v_mfma_f32_32x32x16_bf16 v[16:31], v[92:95], v[96:99], v[16:31]
    ds_read_b64_tr_b16 v[76:77], v119 offset:128
    ds_read_b64_tr_b16 v[78:79], v119 offset:1920
    ds_read_b128 v[100:103], v115
    s_waitcnt lgkmcnt(5)
    v_mfma_f32_32x32x16_bf16 v[32:47], v[64:67], v[96:99], v[32:47]
    ds_read_b64_tr_b16 v[80:81], v119 offset:0
    ds_read_b64_tr_b16 v[82:83], v119 offset:1792
    v_mfma_f32_32x32x16_bf16 v[0:15], v[68:71], v[96:99], v[0:15]
    ds_read_b64_tr_b16 v[84:85], v119 offset:64
    ds_read_b64_tr_b16 v[86:87], v119 offset:1856
    s_waitcnt lgkmcnt(5)
    v_mfma_f32_32x32x16_bf16 v[48:63], v[72:75], v[96:99], v[48:63]
    v_add_u32 v112, 45056, v112
    v_add_u32 v113, 45056, v113
    v_add_u32 v114, 45056, v114
    v_add_u32 v115, 45056, v115
    v_add_u32 v116, 45056, v116
    v_add_u32 v117, 45056, v117
    v_add_u32 v118, 45056, v118
    v_add_u32 v119, 45056, v119
    v_add_u32 v120, 45056, v120
    v_add_u32 v121, 45056, v121
    s_waitcnt lgkmcnt(0)
    s_waitcnt vmcnt(8)
    s_barrier
    ds_read_b64_tr_b16 v[88:89], v120 offset:0
    ds_read_b64_tr_b16 v[90:91], v120 offset:1792
    s_mov_b32 s101, 11993088
    buffer_load_dword v111, v110, s[64:67], s101 offen sc1
    v_mfma_f32_32x32x16_bf16 v[32:47], v[76:79], v[100:103], v[32:47]
    ds_read_b64_tr_b16 v[92:93], v116 offset:0
    ds_read_b64_tr_b16 v[94:95], v116 offset:1792
    ds_read_b128 v[96:99], v112
    v_mfma_f32_32x32x16_bf16 v[0:15], v[80:83], v[100:103], v[0:15]
    ds_read_b64_tr_b16 v[64:65], v116 offset:64
    ds_read_b64_tr_b16 v[66:67], v116 offset:1856
    v_mfma_f32_32x32x16_bf16 v[16:31], v[84:87], v[100:103], v[16:31]
    ds_read_b64_tr_b16 v[68:69], v116 offset:128
    ds_read_b64_tr_b16 v[70:71], v116 offset:1920
    v_add_u32 v125, 6144, v139
    s_waitcnt lgkmcnt(4)
    v_mfma_f32_32x32x16_bf16 v[48:63], v[88:91], v[96:99], v[48:63]
    ds_read_b64_tr_b16 v[72:73], v117 offset:0
    ds_read_b64_tr_b16 v[74:75], v117 offset:1792
    ds_read_b128 v[100:103], v113
    v_mfma_f32_32x32x16_bf16 v[0:15], v[92:95], v[96:99], v[0:15]
    ds_read_b64_tr_b16 v[76:77], v117 offset:64
    ds_read_b64_tr_b16 v[78:79], v117 offset:1856
    s_waitcnt lgkmcnt(5)
    v_mfma_f32_32x32x16_bf16 v[16:31], v[64:67], v[96:99], v[16:31]
    ds_read_b64_tr_b16 v[80:81], v117 offset:128
    ds_read_b64_tr_b16 v[82:83], v117 offset:1920
    s_add_u32 m0, s19, 0
    s_add_u32 s8, s18, 0
    buffer_load_dwordx4 v139, s[52:55], s8 offen lds
    buffer_load_dwordx4 v125, s[52:55], s8 offen offset:1024 lds
    v_mfma_f32_32x32x16_bf16 v[32:47], v[68:71], v[96:99], v[32:47]
    ds_read_b64_tr_b16 v[84:85], v118 offset:64
    ds_read_b64_tr_b16 v[86:87], v118 offset:1856
    s_waitcnt lgkmcnt(4)
    v_mfma_f32_32x32x16_bf16 v[0:15], v[72:75], v[100:103], v[0:15]
    ds_read_b64_tr_b16 v[88:89], v118 offset:128
    ds_read_b64_tr_b16 v[90:91], v118 offset:1920
    ds_read_b128 v[96:99], v114
    v_mfma_f32_32x32x16_bf16 v[16:31], v[76:79], v[100:103], v[16:31]
    ds_read_b64_tr_b16 v[92:93], v118 offset:0
    ds_read_b64_tr_b16 v[94:95], v118 offset:1792
    s_add_u32 m0, s19, 2048
    s_add_u32 s8, s18, 14336
    buffer_load_dwordx4 v139, s[52:55], s8 offen lds
    buffer_load_dwordx4 v125, s[52:55], s8 offen offset:1024 lds
    s_waitcnt lgkmcnt(5)
    v_mfma_f32_32x32x16_bf16 v[32:47], v[80:83], v[100:103], v[32:47]
    ds_read_b64_tr_b16 v[64:65], v121 offset:0
    ds_read_b64_tr_b16 v[66:67], v121 offset:1792
    s_waitcnt lgkmcnt(4)
    v_mfma_f32_32x32x16_bf16 v[16:31], v[84:87], v[96:99], v[16:31]
    ds_read_b64_tr_b16 v[68:69], v119 offset:128
    ds_read_b64_tr_b16 v[70:71], v119 offset:1920
    ds_read_b128 v[100:103], v115
    s_waitcnt lgkmcnt(5)
    v_mfma_f32_32x32x16_bf16 v[32:47], v[88:91], v[96:99], v[32:47]
    ds_read_b64_tr_b16 v[72:73], v119 offset:0
    ds_read_b64_tr_b16 v[74:75], v119 offset:1792
    v_mfma_f32_32x32x16_bf16 v[0:15], v[92:95], v[96:99], v[0:15]
    ds_read_b64_tr_b16 v[76:77], v119 offset:64
    ds_read_b64_tr_b16 v[78:79], v119 offset:1856
    s_waitcnt lgkmcnt(5)
    v_mfma_f32_32x32x16_bf16 v[48:63], v[64:67], v[96:99], v[48:63]
    v_subrev_u32 v112, 90112, v112
    v_subrev_u32 v113, 90112, v113
    v_subrev_u32 v114, 90112, v114
    v_subrev_u32 v115, 90112, v115
    v_subrev_u32 v116, 90112, v116
    v_subrev_u32 v117, 90112, v117
    v_subrev_u32 v118, 90112, v118
    v_subrev_u32 v119, 90112, v119
    v_subrev_u32 v120, 90112, v120
    v_subrev_u32 v121, 90112, v121
    s_waitcnt vmcnt(4)
    v_cmp_ne_u32 vcc, s35, v111
    s_nop 1
    s_cbranch_vccz L_polldcf
L_pollcf:
    buffer_load_dword v111, v110, s[64:67], s101 offen sc1
    s_waitcnt vmcnt(0)
    v_cmp_ne_u32 vcc, s35, v111
    s_nop 1
    s_cbranch_vccz L_polldcf
    s_nop 0
    s_add_u32 s31, s31, 1
    s_cmp_lt_u32 s31, 0x8000
    s_cbranch_scc1 L_pollcf
L_polldcf:
    s_lshl_b32 s8, s6, 2
    s_add_u32 s8, s8, s68
    s_lshl_b32 s8, s8, 9
    s_add_u32 s34, s8, 11927552
    v_and_b32 v122, 31, v140
    v_lshlrev_b32 v122, 4, v122
    buffer_load_dwordx4 v[104:107], v122, s[64:67], s34 offen sc1
    s_waitcnt lgkmcnt(0)
    s_barrier
    ds_read_b64_tr_b16 v[80:81], v120 offset:0
    ds_read_b64_tr_b16 v[82:83], v120 offset:1792
    v_mfma_f32_32x32x16_bf16 v[32:47], v[68:71], v[100:103], v[32:47]
    ds_read_b64_tr_b16 v[84:85], v116 offset:0
    ds_read_b64_tr_b16 v[86:87], v116 offset:1792
    ds_read_b128 v[96:99], v112
    buffer_load_dwordx4 a[32:35], v108, s[64:67], s30 offen offset:0 sc1
    buffer_load_dwordx4 a[36:39], v108, s[64:67], s30 offen offset:512 sc1
    buffer_load_dwordx4 a[40:43], v108, s[64:67], s30 offen offset:1024 sc1
    buffer_load_dwordx4 a[44:47], v109, s[64:67], s30 offen offset:0 sc1
    v_mfma_f32_32x32x16_bf16 v[0:15], v[72:75], v[100:103], v[0:15]
    ds_read_b64_tr_b16 v[88:89], v116 offset:64
    ds_read_b64_tr_b16 v[90:91], v116 offset:1856
    v_mfma_f32_32x32x16_bf16 v[16:31], v[76:79], v[100:103], v[16:31]
    ds_read_b64_tr_b16 v[92:93], v116 offset:128
    ds_read_b64_tr_b16 v[94:95], v116 offset:1920
    s_waitcnt lgkmcnt(4)
    v_mfma_f32_32x32x16_bf16 v[48:63], v[80:83], v[96:99], v[48:63]
    ds_read_b64_tr_b16 v[64:65], v117 offset:0
    ds_read_b64_tr_b16 v[66:67], v117 offset:1792
    ds_read_b128 v[100:103], v113
    s_add_u32 m0, s19, 32768
    s_add_u32 s8, s18, 28672
    buffer_load_dwordx4 v139, s[52:55], s8 offen lds
    buffer_load_dwordx4 v125, s[52:55], s8 offen offset:1024 lds
    v_mfma_f32_32x32x16_bf16 v[0:15], v[84:87], v[96:99], v[0:15]
    ds_read_b64_tr_b16 v[68:69], v117 offset:64
    ds_read_b64_tr_b16 v[70:71], v117 offset:1856
    s_waitcnt lgkmcnt(5)
    v_mfma_f32_32x32x16_bf16 v[16:31], v[88:91], v[96:99], v[16:31]
    ds_read_b64_tr_b16 v[72:73], v117 offset:128
    ds_read_b64_tr_b16 v[74:75], v117 offset:1920
    v_mfma_f32_32x32x16_bf16 v[32:47], v[92:95], v[96:99], v[32:47]
    ds_read_b64_tr_b16 v[76:77], v118 offset:64
    ds_read_b64_tr_b16 v[78:79], v118 offset:1856
    s_add_u32 m0, s19, 34816
    s_add_u32 s8, s18, 43008
    buffer_load_dwordx4 v139, s[52:55], s8 offen lds
    buffer_load_dwordx4 v125, s[52:55], s8 offen offset:1024 lds
    s_waitcnt lgkmcnt(4)
    v_mfma_f32_32x32x16_bf16 v[0:15], v[64:67], v[100:103], v[0:15]
    ds_read_b64_tr_b16 v[80:81], v118 offset:128
    ds_read_b64_tr_b16 v[82:83], v118 offset:1920
    ds_read_b128 v[96:99], v114
    v_mfma_f32_32x32x16_bf16 v[16:31], v[68:71], v[100:103], v[16:31]
    ds_read_b64_tr_b16 v[84:85], v118 offset:0
    ds_read_b64_tr_b16 v[86:87], v118 offset:1792
    s_waitcnt lgkmcnt(5)
    v_mfma_f32_32x32x16_bf16 v[32:47], v[72:75], v[100:103], v[32:47]
    ds_read_b64_tr_b16 v[88:89], v121 offset:0
    ds_read_b64_tr_b16 v[90:91], v121 offset:1792
    s_waitcnt lgkmcnt(4)
    v_mfma_f32_32x32x16_bf16 v[16:31], v[76:79], v[96:99], v[16:31]
    ds_read_b64_tr_b16 v[92:93], v119 offset:128
    ds_read_b64_tr_b16 v[94:95], v119 offset:1920
    ds_read_b128 v[100:103], v115
    s_waitcnt lgkmcnt(5)
    v_mfma_f32_32x32x16_bf16 v[32:47], v[80:83], v[96:99], v[32:47]
    ds_read_b64_tr_b16 v[64:65], v119 offset:0
    ds_read_b64_tr_b16 v[66:67], v119 offset:1792
    v_mfma_f32_32x32x16_bf16 v[0:15], v[84:87], v[96:99], v[0:15]
    ds_read_b64_tr_b16 v[68:69], v119 offset:64
    ds_read_b64_tr_b16 v[70:71], v119 offset:1856
    s_waitcnt lgkmcnt(5)
    v_mfma_f32_32x32x16_bf16 v[48:63], v[88:91], v[96:99], v[48:63]
    s_waitcnt lgkmcnt(4)
    v_mfma_f32_32x32x16_bf16 v[32:47], v[92:95], v[100:103], v[32:47]
    s_waitcnt lgkmcnt(0)
    v_mfma_f32_32x32x16_bf16 v[0:15], v[64:67], v[100:103], v[0:15]
    v_mfma_f32_32x32x16_bf16 v[16:31], v[68:71], v[100:103], v[16:31]
    s_lshl_b32 s25, s4, 11
    s_add_u32 s25, s25, 144384
    s_sub_u32 s8, s25, s19
    v_add_u32 v126, s8, v142
    v_add_u32 v127, s8, v143
    s_xor_b32 s8, s4, 4
    s_lshl_b32 s8, s8, 11
    s_add_u32 s8, s8, 144384
    v_add_u32 v112, s8, v141
    s_lshl_b32 s8, s4, 11
    s_add_u32 s8, s8, 144384
    v_add_u32 v113, s8, v141
    ds_write_b128 v112, v[56:59] offset:0
    ds_write_b128 v112, v[60:63] offset:1024
    s_waitcnt vmcnt(8)
    v_cmp_ne_u32 vcc, s35, v106
    s_nop 1
    s_cbranch_vccz L_gotrf
L_spinrf:
    buffer_load_dwordx4 v[104:107], v122, s[64:67], s34 offen sc1
    s_waitcnt vmcnt(0)
    v_cmp_ne_u32 vcc, s35, v106
    s_nop 1
    s_cbranch_vccz L_gotrf
    s_nop 0
    s_add_u32 s31, s31, 1
    s_cmp_lt_u32 s31, 0x8000
    s_cbranch_scc1 L_spinrf
L_gotrf:
    v_cvt_pk_bf16_f32 v96, v104, v104
    v_cvt_pk_bf16_f32 v97, v104, v104
    v_cvt_pk_bf16_f32 v98, v104, v104
    v_cvt_pk_bf16_f32 v99, v104, v104
    v_mul_f32 v104, 0xbfb8aa3b, v105
    s_waitcnt vmcnt(7)
    v_mfma_f32_32x32x16_bf16 v[0:15], a[32:35], v[96:99], v[0:15]
    s_waitcnt vmcnt(6)
    v_mfma_f32_32x32x16_bf16 v[16:31], a[36:39], v[96:99], v[16:31]
    s_waitcnt vmcnt(5)
    v_mfma_f32_32x32x16_bf16 v[32:47], a[40:43], v[96:99], v[32:47]
    s_waitcnt vmcnt(4)
    v_mfma_f32_32x32x16_bf16 v[48:63], a[44:47], v[96:99], v[48:63]
    s_waitcnt lgkmcnt(0)
    s_barrier
    ds_read_b128 v[116:119], v113 offset:0
    ds_read_b128 v[120:123], v113 offset:1024
    s_lshl_b32 s8, s6, 2
    s_add_u32 s8, s8, s68
    s_mul_i32 s9, s8, 114688
    s_lshl_b32 s8, s8, 3
    s_add_u32 s8, s8, s5
    s_lshl_b32 s8, s8, 1
    s_add_u32 s8, s8, s69
    s_lshl_b32 s8, s8, 7
    s_add_u32 s0, s8, 11534336
    s_mul_i32 s10, s5, 14336
    s_add_u32 s9, s9, s10
    s_mul_i32 s10, s69, 6144
    s_add_u32 s10, s9, s10
    s_lshl_b32 s11, s69, 10
    s_add_u32 s9, s9, s11
    s_add_u32 s1, s9, 12288
    v_pk_mul_f32 v[0:1], v[0:1], v[104:105] op_sel_hi:[1,0]
    v_pk_mul_f32 v[2:3], v[2:3], v[104:105] op_sel_hi:[1,0]
    v_pk_mul_f32 v[4:5], v[4:5], v[104:105] op_sel_hi:[1,0]
    v_pk_mul_f32 v[6:7], v[6:7], v[104:105] op_sel_hi:[1,0]
    v_exp_f32 v64, v0
    v_exp_f32 v65, v1
    v_exp_f32 v66, v2
    v_exp_f32 v67, v3
    v_exp_f32 v68, v4
    v_exp_f32 v69, v5
    v_exp_f32 v70, v6
    v_exp_f32 v71, v7
    v_pk_add_f32 v[64:65], v[64:65], 1.0 op_sel_hi:[1,0]
    v_pk_add_f32 v[66:67], v[66:67], 1.0 op_sel_hi:[1,0]
    v_pk_add_f32 v[68:69], v[68:69], 1.0 op_sel_hi:[1,0]
    v_pk_add_f32 v[70:71], v[70:71], 1.0 op_sel_hi:[1,0]
    v_rcp_f32 v64, v64
    v_rcp_f32 v65, v65
    v_rcp_f32 v66, v66
    v_rcp_f32 v67, v67
    ds_read_b64_tr_b16 a[0:1], v142 offset:0
    ds_read_b64_tr_b16 a[2:3], v142 offset:1024
    ds_read_b64_tr_b16 a[4:5], v143 offset:0
    ds_read_b64_tr_b16 a[6:7], v143 offset:1024
    ds_read_b64_tr_b16 a[8:9], v142 offset:2048
    ds_read_b64_tr_b16 a[10:11], v142 offset:3072
    ds_read_b64_tr_b16 a[12:13], v143 offset:2048
    ds_read_b64_tr_b16 a[14:15], v143 offset:3072
    s_waitcnt vmcnt(2)
    ds_read_b64_tr_b16 a[16:17], v142 offset:32768
    ds_read_b64_tr_b16 a[18:19], v142 offset:33792
    ds_read_b64_tr_b16 a[20:21], v143 offset:32768
    ds_read_b64_tr_b16 a[22:23], v143 offset:33792
    s_waitcnt vmcnt(0)
    ds_read_b64_tr_b16 a[24:25], v142 offset:34816
    ds_read_b64_tr_b16 a[26:27], v142 offset:35840
    ds_read_b64_tr_b16 a[28:29], v143 offset:34816
    ds_read_b64_tr_b16 a[30:31], v143 offset:35840
    v_rcp_f32 v68, v68
    v_rcp_f32 v69, v69
    v_rcp_f32 v70, v70
    v_rcp_f32 v71, v71
    v_pk_mul_f32 v[64:65], v[64:65], v[0:1]
    v_pk_mul_f32 v[66:67], v[66:67], v[2:3]
    v_pk_mul_f32 v[68:69], v[68:69], v[4:5]
    v_pk_mul_f32 v[70:71], v[70:71], v[6:7]
    v_cvt_pk_bf16_f32 v80, v64, v65
    v_cvt_pk_bf16_f32 v81, v66, v67
    v_cvt_pk_bf16_f32 v82, v68, v69
    v_cvt_pk_bf16_f32 v83, v70, v71
    buffer_store_dwordx4 v[80:83], v141, s[64:67], s10 offen offset:0 sc1
    v_pk_mul_f32 v[8:9], v[8:9], v[104:105] op_sel_hi:[1,0]
    v_pk_mul_f32 v[10:11], v[10:11], v[104:105] op_sel_hi:[1,0]
    v_pk_mul_f32 v[12:13], v[12:13], v[104:105] op_sel_hi:[1,0]
    v_pk_mul_f32 v[14:15], v[14:15], v[104:105] op_sel_hi:[1,0]
    v_exp_f32 v72, v8
    v_exp_f32 v73, v9
    v_exp_f32 v74, v10
    s_mov_b32 m0, s25
    s_add_u32 s8, s18, 57344
    s_waitcnt lgkmcnt(15)
    buffer_load_dwordx4 v139, s[52:55], s8 offen lds
    buffer_load_dwordx4 v125, s[52:55], s8 offen offset:1024 lds
    v_exp_f32 v75, v11
    v_exp_f32 v76, v12
    v_exp_f32 v77, v13
    v_exp_f32 v78, v14
    v_exp_f32 v79, v15
    v_pk_add_f32 v[72:73], v[72:73], 1.0 op_sel_hi:[1,0]
    v_pk_add_f32 v[74:75], v[74:75], 1.0 op_sel_hi:[1,0]
    v_pk_add_f32 v[76:77], v[76:77], 1.0 op_sel_hi:[1,0]
    v_pk_add_f32 v[78:79], v[78:79], 1.0 op_sel_hi:[1,0]
    v_rcp_f32 v72, v72
    v_rcp_f32 v73, v73
    v_rcp_f32 v74, v74
    v_rcp_f32 v75, v75
    v_rcp_f32 v76, v76
    v_rcp_f32 v77, v77
    v_rcp_f32 v78, v78
    v_rcp_f32 v79, v79
    v_pk_mul_f32 v[72:73], v[72:73], v[8:9]
    v_pk_mul_f32 v[74:75], v[74:75], v[10:11]
    v_pk_mul_f32 v[76:77], v[76:77], v[12:13]
    s_add_u32 m0, s19, 0
    s_add_u32 s8, s18, 71680
    s_waitcnt lgkmcnt(12)
    buffer_load_dwordx4 v139, s[52:55], s8 offen lds
    buffer_load_dwordx4 v125, s[52:55], s8 offen offset:1024 lds
    v_pk_mul_f32 v[78:79], v[78:79], v[14:15]
    v_cvt_pk_bf16_f32 v84, v72, v73
    v_cvt_pk_bf16_f32 v85, v74, v75
    v_cvt_pk_bf16_f32 v86, v76, v77
    v_cvt_pk_bf16_f32 v87, v78, v79
    buffer_store_dwordx4 v[84:87], v141, s[64:67], s10 offen offset:1024 sc1
    v_pk_mul_f32 v[16:17], v[16:17], v[104:105] op_sel_hi:[1,0]
    v_pk_mul_f32 v[18:19], v[18:19], v[104:105] op_sel_hi:[1,0]
    v_pk_mul_f32 v[20:21], v[20:21], v[104:105] op_sel_hi:[1,0]
    v_pk_mul_f32 v[22:23], v[22:23], v[104:105] op_sel_hi:[1,0]
    v_exp_f32 v64, v16
    v_exp_f32 v65, v17
    v_exp_f32 v66, v18
    v_exp_f32 v67, v19
    v_exp_f32 v68, v20
    v_exp_f32 v69, v21
    v_exp_f32 v70, v22
    v_exp_f32 v71, v23
    v_pk_add_f32 v[64:65], v[64:65], 1.0 op_sel_hi:[1,0]
    v_pk_add_f32 v[66:67], v[66:67], 1.0 op_sel_hi:[1,0]
    s_add_u32 m0, s19, 2048
    s_add_u32 s8, s18, 86016
    s_waitcnt lgkmcnt(8)
    buffer_load_dwordx4 v139, s[52:55], s8 offen lds
    buffer_load_dwordx4 v125, s[52:55], s8 offen offset:1024 lds
    v_pk_add_f32 v[68:69], v[68:69], 1.0 op_sel_hi:[1,0]
    v_pk_add_f32 v[70:71], v[70:71], 1.0 op_sel_hi:[1,0]
    v_rcp_f32 v64, v64
    v_rcp_f32 v65, v65
    v_rcp_f32 v66, v66
    v_rcp_f32 v67, v67
    v_rcp_f32 v68, v68
    v_rcp_f32 v69, v69
    v_rcp_f32 v70, v70
    v_rcp_f32_e64 v71, v71
    v_pk_mul_f32 v[64:65], v[64:65], v[16:17]
    v_pk_mul_f32 v[66:67], v[66:67], v[18:19]
    v_pk_mul_f32 v[68:69], v[68:69], v[20:21]
    v_pk_mul_f32 v[70:71], v[70:71], v[22:23]
    v_cvt_pk_bf16_f32 v80, v64, v65
    v_cvt_pk_bf16_f32 v81, v66, v67
    v_cvt_pk_bf16_f32 v82, v68, v69
    v_cvt_pk_bf16_f32 v83, v70, v71
    buffer_store_dwordx4 v[80:83], v141, s[64:67], s10 offen offset:2048 sc1
    v_pk_mul_f32 v[24:25], v[24:25], v[104:105] op_sel_hi:[1,0]
    s_add_u32 m0, s19, 32768
    s_add_u32 s8, s18, 100352
    s_waitcnt lgkmcnt(4)
    buffer_load_dwordx4 v139, s[52:55], s8 offen lds
    buffer_load_dwordx4 v125, s[52:55], s8 offen offset:1024 lds
    v_pk_mul_f32 v[26:27], v[26:27], v[104:105] op_sel_hi:[1,0]
    v_pk_mul_f32 v[28:29], v[28:29], v[104:105] op_sel_hi:[1,0]
    v_pk_mul_f32 v[30:31], v[30:31], v[104:105] op_sel_hi:[1,0]
    v_exp_f32 v72, v24
    v_exp_f32 v73, v25
    v_exp_f32 v74, v26
    v_exp_f32 v75, v27
    v_exp_f32 v76, v28
    v_exp_f32 v77, v29
    v_exp_f32 v78, v30
    v_exp_f32_e64 v79, v31
    v_pk_add_f32 v[72:73], v[72:73], 1.0 op_sel_hi:[1,0]
    v_pk_add_f32 v[74:75], v[74:75], 1.0 op_sel_hi:[1,0]
    v_pk_add_f32 v[76:77], v[76:77], 1.0 op_sel_hi:[1,0]
    v_pk_add_f32 v[78:79], v[78:79], 1.0 op_sel_hi:[1,0]
    v_rcp_f32 v72, v72
    v_rcp_f32 v73, v73
    v_rcp_f32 v74, v74
    v_rcp_f32 v75, v75
    v_rcp_f32 v76, v76
    s_add_u32 m0, s19, 34816
    s_add_u32 s8, s18, 114688
    s_waitcnt lgkmcnt(0)
    buffer_load_dwordx4 v139, s[52:55], s8 offen lds
    buffer_load_dwordx4 v125, s[52:55], s8 offen offset:1024 lds
    v_rcp_f32 v77, v77
    v_rcp_f32 v78, v78
    v_rcp_f32_e64 v79, v79
    v_pk_mul_f32 v[72:73], v[72:73], v[24:25]
    v_pk_mul_f32 v[74:75], v[74:75], v[26:27]
    v_pk_mul_f32 v[76:77], v[76:77], v[28:29]
    v_pk_mul_f32 v[78:79], v[78:79], v[30:31]
    v_cvt_pk_bf16_f32 v84, v72, v73
    v_cvt_pk_bf16_f32 v85, v74, v75
    v_cvt_pk_bf16_f32 v86, v76, v77
    v_cvt_pk_bf16_f32 v87, v78, v79
    buffer_store_dwordx4 v[84:87], v141, s[64:67], s10 offen offset:3072 sc1
    v_pk_mul_f32 v[32:33], v[32:33], v[104:105] op_sel_hi:[1,0]
    v_pk_mul_f32 v[34:35], v[34:35], v[104:105] op_sel_hi:[1,0]
    v_pk_mul_f32 v[36:37], v[36:37], v[104:105] op_sel_hi:[1,0]
    v_pk_mul_f32 v[38:39], v[38:39], v[104:105] op_sel_hi:[1,0]
    v_exp_f32 v64, v32
    v_exp_f32 v65, v33
    v_exp_f32 v66, v34
    v_exp_f32 v67, v35
    v_exp_f32 v68, v36
    v_exp_f32 v69, v37
    v_exp_f32 v70, v38
    v_exp_f32 v71, v39
    v_pk_add_f32 v[64:65], v[64:65], 1.0 op_sel_hi:[1,0]
    v_pk_add_f32 v[66:67], v[66:67], 1.0 op_sel_hi:[1,0]
    v_pk_add_f32 v[68:69], v[68:69], 1.0 op_sel_hi:[1,0]
    v_pk_add_f32 v[70:71], v[70:71], 1.0 op_sel_hi:[1,0]
    v_rcp_f32 v64, v64
    v_rcp_f32 v65, v65
    v_rcp_f32 v66, v66
    v_rcp_f32 v67, v67
    v_rcp_f32 v68, v68
    v_rcp_f32 v69, v69
    v_rcp_f32 v70, v70
    v_rcp_f32 v71, v71
    v_pk_mul_f32 v[64:65], v[64:65], v[32:33]
    v_pk_mul_f32 v[66:67], v[66:67], v[34:35]
    v_pk_mul_f32 v[68:69], v[68:69], v[36:37]
    v_pk_mul_f32 v[70:71], v[70:71], v[38:39]
    v_cvt_pk_bf16_f32 v80, v64, v65
    v_cvt_pk_bf16_f32 v81, v66, v67
    v_cvt_pk_bf16_f32 v82, v68, v69
    v_cvt_pk_bf16_f32 v83, v70, v71
    s_add_u32 s10, s10, 4096
    buffer_store_dwordx4 v[80:83], v141, s[64:67], s10 offen offset:0 sc1
    v_pk_mul_f32 v[40:41], v[40:41], v[104:105] op_sel_hi:[1,0]
    v_pk_mul_f32 v[42:43], v[42:43], v[104:105] op_sel_hi:[1,0]
    v_pk_mul_f32 v[44:45], v[44:45], v[104:105] op_sel_hi:[1,0]
    v_pk_mul_f32 v[46:47], v[46:47], v[104:105] op_sel_hi:[1,0]
    v_exp_f32 v72, v40
    v_exp_f32 v73, v41
    v_exp_f32 v74, v42
    v_exp_f32 v75, v43
    v_exp_f32 v76, v44
    v_exp_f32 v77, v45
    v_exp_f32 v78, v46
    v_exp_f32 v79, v47
    v_pk_add_f32 v[72:73], v[72:73], 1.0 op_sel_hi:[1,0]
    v_pk_add_f32 v[74:75], v[74:75], 1.0 op_sel_hi:[1,0]
    v_pk_add_f32 v[76:77], v[76:77], 1.0 op_sel_hi:[1,0]
    v_pk_add_f32 v[78:79], v[78:79], 1.0 op_sel_hi:[1,0]
    v_rcp_f32 v72, v72
    v_rcp_f32 v73, v73
    v_rcp_f32 v74, v74
    v_rcp_f32 v75, v75
    v_rcp_f32 v76, v76
    v_rcp_f32 v77, v77
    v_rcp_f32 v78, v78
    v_rcp_f32 v79, v79
    v_pk_mul_f32 v[72:73], v[72:73], v[40:41]
    v_pk_mul_f32 v[74:75], v[74:75], v[42:43]
    v_pk_mul_f32 v[76:77], v[76:77], v[44:45]
    v_pk_mul_f32 v[78:79], v[78:79], v[46:47]
    v_cvt_pk_bf16_f32 v84, v72, v73
    v_cvt_pk_bf16_f32 v85, v74, v75
    v_cvt_pk_bf16_f32 v86, v76, v77
    v_cvt_pk_bf16_f32 v87, v78, v79
    buffer_store_dwordx4 v[84:87], v141, s[64:67], s10 offen offset:1024 sc1
    v_pk_add_f32 v[48:49], v[48:49], v[116:117]
    v_pk_add_f32 v[50:51], v[50:51], v[118:119]
    v_pk_add_f32 v[52:53], v[52:53], v[120:121]
    v_pk_add_f32 v[54:55], v[54:55], v[122:123]
    v_pk_mul_f32 v[48:49], v[48:49], v[104:105] op_sel_hi:[1,0]
    v_pk_mul_f32 v[50:51], v[50:51], v[104:105] op_sel_hi:[1,0]
    v_pk_mul_f32 v[52:53], v[52:53], v[104:105] op_sel_hi:[1,0]
    v_pk_mul_f32 v[54:55], v[54:55], v[104:105] op_sel_hi:[1,0]
    v_exp_f32 v64, v48
    v_exp_f32 v65, v49
    v_exp_f32 v66, v50
    v_exp_f32 v67, v51
    v_exp_f32 v68, v52
    v_exp_f32 v69, v53
    v_exp_f32 v70, v54
    v_exp_f32 v71, v55
    v_pk_add_f32 v[64:65], v[64:65], 1.0 op_sel_hi:[1,0]
    v_pk_add_f32 v[66:67], v[66:67], 1.0 op_sel_hi:[1,0]
    v_pk_add_f32 v[68:69], v[68:69], 1.0 op_sel_hi:[1,0]
    v_pk_add_f32 v[70:71], v[70:71], 1.0 op_sel_hi:[1,0]
    v_rcp_f32 v64, v64
    v_rcp_f32 v65, v65
    v_rcp_f32 v66, v66
    v_rcp_f32 v67, v67
    v_rcp_f32 v68, v68
    v_rcp_f32 v69, v69
    v_rcp_f32 v70, v70
    v_rcp_f32 v71, v71
    v_pk_mul_f32 v[64:65], v[64:65], v[48:49]
    v_pk_mul_f32 v[66:67], v[66:67], v[50:51]
    v_pk_mul_f32 v[68:69], v[68:69], v[52:53]
    v_pk_mul_f32 v[70:71], v[70:71], v[54:55]
    v_cvt_pk_bf16_f32 v80, v64, v65
    v_cvt_pk_bf16_f32 v81, v66, v67
    v_cvt_pk_bf16_f32 v82, v68, v69
    v_cvt_pk_bf16_f32 v83, v70, v71
    buffer_store_dwordx4 v[80:83], v141, s[64:67], s1 offen sc1
    s_setprio 0
    v_accvgpr_read_b32 v129, a72
    v_accvgpr_read_b32 v130, a73
    v_accvgpr_read_b32 v131, a74
    v_accvgpr_read_b32 v136, a75
    v_accvgpr_read_b32 v137, a76
    v_accvgpr_read_b32 v138, a77
    s_waitcnt vmcnt(14)
    ds_read_b64_tr_b16 a[32:33], v126 offset:0
    ds_read_b64_tr_b16 a[34:35], v126 offset:1024
    ds_read_b64_tr_b16 a[36:37], v127 offset:0
    ds_read_b64_tr_b16 a[38:39], v127 offset:1024
    s_waitcnt vmcnt(12)
    ds_read_b64_tr_b16 a[40:41], v142 offset:0
    ds_read_b64_tr_b16 a[42:43], v142 offset:1024
    ds_read_b64_tr_b16 a[44:45], v143 offset:0
    ds_read_b64_tr_b16 a[46:47], v143 offset:1024
    s_waitcnt vmcnt(9)
    ds_read_b64_tr_b16 a[48:49], v142 offset:2048
    ds_read_b64_tr_b16 a[50:51], v142 offset:3072
    ds_read_b64_tr_b16 a[52:53], v143 offset:2048
    ds_read_b64_tr_b16 a[54:55], v143 offset:3072
    s_waitcnt vmcnt(6)
    ds_read_b64_tr_b16 a[56:57], v142 offset:32768
    ds_read_b64_tr_b16 a[58:59], v142 offset:33792
    ds_read_b64_tr_b16 a[60:61], v143 offset:32768
    ds_read_b64_tr_b16 a[62:63], v143 offset:33792
    s_waitcnt vmcnt(4)
    ds_read_b64_tr_b16 a[64:65], v142 offset:34816
    ds_read_b64_tr_b16 a[66:67], v142 offset:35840
    ds_read_b64_tr_b16 a[68:69], v143 offset:34816
    ds_read_b64_tr_b16 a[70:71], v143 offset:35840
    v_mov_b32 v96, s35
    v_mov_b32 v97, 0
    s_mov_b64 exec, 1
    s_waitcnt vmcnt(0)
    buffer_store_dword v96, v97, s[64:67], s0 offen sc1
    s_mov_b64 exec, -1
    s_barrier
    s_mov_b32 m0, s25
    s_add_u32 s8, s18, 129024
    s_waitcnt lgkmcnt(15)
    buffer_load_dwordx4 v139, s[52:55], s8 offen lds
    buffer_load_dwordx4 v125, s[52:55], s8 offen offset:1024 lds
    s_add_u32 m0, s19, 0
    s_add_u32 s8, s18, 143360
    s_waitcnt lgkmcnt(12)
    buffer_load_dwordx4 v139, s[52:55], s8 offen lds
    buffer_load_dwordx4 v125, s[52:55], s8 offen offset:1024 lds
    s_add_u32 m0, s19, 2048
    s_add_u32 s8, s18, 157696
    s_waitcnt lgkmcnt(8)
    buffer_load_dwordx4 v139, s[52:55], s8 offen lds
    buffer_load_dwordx4 v125, s[52:55], s8 offen offset:1024 lds
    buffer_load_dword v128, v129, s[64:67], s98 offen sc1
    s_add_u32 m0, s19, 32768
    s_add_u32 s8, s18, 172032
    s_waitcnt lgkmcnt(4)
    buffer_load_dwordx4 v139, s[52:55], s8 offen lds
    buffer_load_dwordx4 v125, s[52:55], s8 offen offset:1024 lds
    s_add_u32 m0, s19, 34816
    s_add_u32 s8, s18, 186368
    s_waitcnt lgkmcnt(0)
    buffer_load_dwordx4 v139, s[52:55], s8 offen lds
    buffer_load_dwordx4 v125, s[52:55], s8 offen offset:1024 lds
    s_waitcnt lgkmcnt(0)
    s_waitcnt vmcnt(4)
    s_nop 0
    s_branch L_p2
    s_nop 0
L_q:
    s_lshl_b32 s8, s6, 1
    s_add_u32 s8, s8, s5
    s_lshl_b32 s0, s4, 5
    s_add_u32 s0, s0, s8
    s_cmp_ge_u32 s0, 196
    s_cbranch_scc1 L_nocl
    s_lshr_b32 s9, s0, 2
    s_mov_b32 s1, 2688
    s_cmp_lt_u32 s9, 28
    s_cselect_b64 s[10:11], s[26:27], s[18:19]
    s_cselect_b32 s1, 3584, s1
    s_cselect_b32 s8, 0, 28
    s_sub_u32 s9, s9, s8
    s_lshl_b32 s9, s9, 7
    s_and_b32 s8, s0, 3
    s_mul_i32 s8, s8, 112
    s_mul_i32 s8, s8, s1
    s_add_u32 s9, s9, s8
    v_lshrrev_b32 v8, 3, v0
    v_mul_lo_u32 v8, v8, s1
    v_and_b32 v9, 7, v0
    v_lshl_add_u32 v8, v9, 4, v8
    v_add_u32 v8, s9, v8
    s_lshl_b32 s8, s1, 3
    global_load_dwordx4 v[16:19], v8, s[10:11]
    v_add_u32 v8, s8, v8
    global_load_dwordx4 v[20:23], v8, s[10:11]
    v_add_u32 v8, s8, v8
    global_load_dwordx4 v[24:27], v8, s[10:11]
    v_add_u32 v8, s8, v8
    global_load_dwordx4 v[28:31], v8, s[10:11]
    v_add_u32 v8, s8, v8
    global_load_dwordx4 v[32:35], v8, s[10:11]
    v_add_u32 v8, s8, v8
    global_load_dwordx4 v[36:39], v8, s[10:11]
    v_add_u32 v8, s8, v8
    global_load_dwordx4 v[40:43], v8, s[10:11]
    v_add_u32 v8, s8, v8
    global_load_dwordx4 v[44:47], v8, s[10:11]
    v_add_u32 v8, s8, v8
    global_load_dwordx4 v[48:51], v8, s[10:11]
    v_add_u32 v8, s8, v8
    global_load_dwordx4 v[52:55], v8, s[10:11]
    v_add_u32 v8, s8, v8
    global_load_dwordx4 v[56:59], v8, s[10:11]
    v_add_u32 v8, s8, v8
    global_load_dwordx4 v[60:63], v8, s[10:11]
    v_add_u32 v8, s8, v8
    global_load_dwordx4 v[80:83], v8, s[10:11]
    v_add_u32 v8, s8, v8
    global_load_dwordx4 v[84:87], v8, s[10:11]
L_nocl:
    s_mov_b32 s40, s18
    s_and_b32 s41, s19, 0xffff
    s_mov_b32 s42, 1204224
    s_mov_b32 s43, 0x20000
    v_mul_u32_u24 v6, 2688, v6
    v_lshl_add_u32 v124, v7, 4, v6
    s_mul_i32 s13, s5, 448
    s_mul_i32 s10, s69, 224
    s_add_u32 s10, s10, 16384
    v_and_b32 v128, 31, v0
    v_lshlrev_b32 v128, 7, v128
    s_lshl_b32 s8, s68, 12
    v_add_u32 v128, s8, v128
    v_lshrrev_b32 v129, 5, v0
    v_bfe_u32 v130, v0, 1, 3
    v_xor_b32 v130, v130, v129
    v_lshlrev_b32 v131, 3, v129
    v_bfe_u32 v132, v0, 2, 2
    v_add_u32 v131, v131, v132
    v_mul_u32_u24 v131, 448, v131
    v_bfe_u32 v132, v0, 4, 1
    v_and_b32 v133, 3, v0
    v_lshl_add_u32 v132, v132, 2, v133
    v_min_u32 v132, 6, v132
    v_lshl_add_u32 v131, v132, 3, v131
    v_add_u32 v131, s10, v131
    s_add_u32 s8, s68, s69
    s_add_u32 s8, s8, 0
    s_and_b32 s8, s8, 3
    s_lshl_b32 s9, s8, 1
    v_xor_b32 v133, s9, v130
    v_lshl_add_u32 v112, v133, 4, v128
    s_mul_i32 s9, s8, 7168
    v_add_u32 v116, s9, v131
    s_add_u32 s8, s68, s69
    s_add_u32 s8, s8, 1
    s_and_b32 s8, s8, 3
    s_lshl_b32 s9, s8, 1
    v_xor_b32 v133, s9, v130
    v_lshl_add_u32 v113, v133, 4, v128
    s_mul_i32 s9, s8, 7168
    v_add_u32 v117, s9, v131
    s_add_u32 s8, s68, s69
    s_add_u32 s8, s8, 2
    s_and_b32 s8, s8, 3
    s_lshl_b32 s9, s8, 1
    v_xor_b32 v133, s9, v130
    v_lshl_add_u32 v114, v133, 4, v128
    s_mul_i32 s9, s8, 7168
    v_add_u32 v118, s9, v131
    s_add_u32 s8, s68, s69
    s_add_u32 s8, s8, 3
    s_and_b32 s8, s8, 3
    s_lshl_b32 s9, s8, 1
    v_xor_b32 v133, s9, v130
    v_lshl_add_u32 v115, v133, 4, v128
    s_mul_i32 s9, s8, 7168
    v_add_u32 v119, s9, v131
    s_mov_b32 s44, s20
    s_and_b32 s45, s21, 0xffff
    s_mov_b32 s46, 25088
    s_mov_b32 s47, 0x20000
    s_mov_b32 s48, s22
    s_and_b32 s49, s23, 0xffff
    s_mov_b32 s50, 401408
    s_mov_b32 s51, 0x20000
    s_mov_b32 s52, s28
    s_and_b32 s53, s29, 0xffff
    s_mov_b32 s54, 1605632
    s_mov_b32 s55, 0x20000
    s_mov_b32 s56, s30
    s_and_b32 s57, s31, 0xffff
    s_mov_b32 s58, 1835008
    s_mov_b32 s59, 0x20000
    s_mov_b32 s26, 0x3fb8aa3b
    s_mov_b32 s27, 0x3fb8aa3b
    s_mov_b32 s28, 0
    s_mov_b32 s29, -1
    s_mov_b32 s31, 0
    s_lshl_b32 s24, s5, 3
    v_and_b32 v64, 31, v140
    v_mov_b32 v66, 0x7f000000
    v_subrev_u32 v65, 4, v64
    v_cmp_lt_u32 vcc, 27, v64
    s_nop 1
    v_cndmask_b32 v64, v64, v65, vcc
    v_lshlrev_b32 v64, 4, v64
    v_cndmask_b32 v108, v64, v66, s[28:29]
    v_and_b32 v64, 31, v140
    v_lshlrev_b32 v110, 7, v64
    s_mul_i32 s8, s5, 224
    s_mul_i32 s9, s69, 112
    s_add_u32 s8, s8, s9
    s_add_u32 s8, s8, 1792
    s_lshl_b32 s8, s8, 4
    s_add_u32 s30, s8, 12058624
    s_mov_b32 s8, 0x00003f80
    s_mov_b32 s9, 0x3f800000
    s_cmp_ge_u32 s0, 196
    s_cbranch_scc1 L_nocs
    s_waitcnt vmcnt(12)
    v_dot2_f32_bf16 v88, v16, s8, 0
    v_dot2_f32_bf16 v89, v16, s9, 0
    v_dot2_f32_bf16 v90, v17, s8, 0
    v_dot2_f32_bf16 v91, v17, s9, 0
    v_dot2_f32_bf16 v92, v18, s8, 0
    v_dot2_f32_bf16 v93, v18, s9, 0
    v_dot2_f32_bf16 v94, v19, s8, 0
    v_dot2_f32_bf16 v95, v19, s9, 0
    v_dot2_f32_bf16 v88, v20, s8, v88
    v_dot2_f32_bf16 v89, v20, s9, v89
    v_dot2_f32_bf16 v90, v21, s8, v90
    v_dot2_f32_bf16 v91, v21, s9, v91
    v_dot2_f32_bf16 v92, v22, s8, v92
    v_dot2_f32_bf16 v93, v22, s9, v93
    v_dot2_f32_bf16 v94, v23, s8, v94
    v_dot2_f32_bf16 v95, v23, s9, v95
    s_waitcnt vmcnt(10)
    s_nop 0
    v_dot2_f32_bf16 v88, v24, s8, v88
    v_dot2_f32_bf16 v89, v24, s9, v89
    v_dot2_f32_bf16 v90, v25, s8, v90
    v_dot2_f32_bf16 v91, v25, s9, v91
    v_dot2_f32_bf16 v92, v26, s8, v92
    v_dot2_f32_bf16 v93, v26, s9, v93
    v_dot2_f32_bf16 v94, v27, s8, v94
    v_dot2_f32_bf16 v95, v27, s9, v95
    v_dot2_f32_bf16 v88, v28, s8, v88
    v_dot2_f32_bf16 v89, v28, s9, v89
    v_dot2_f32_bf16 v90, v29, s8, v90
    v_dot2_f32_bf16 v91, v29, s9, v91
    v_dot2_f32_bf16 v92, v30, s8, v92
    v_dot2_f32_bf16 v93, v30, s9, v93
    v_dot2_f32_bf16 v94, v31, s8, v94
    v_dot2_f32_bf16 v95, v31, s9, v95
    s_waitcnt vmcnt(8)
    s_nop 0
    v_dot2_f32_bf16 v88, v32, s8, v88
    v_dot2_f32_bf16 v89, v32, s9, v89
    v_dot2_f32_bf16 v90, v33, s8, v90
    v_dot2_f32_bf16 v91, v33, s9, v91
    v_dot2_f32_bf16 v92, v34, s8, v92
    v_dot2_f32_bf16 v93, v34, s9, v93
    v_dot2_f32_bf16 v94, v35, s8, v94
    v_dot2_f32_bf16 v95, v35, s9, v95
    v_dot2_f32_bf16 v88, v36, s8, v88
    v_dot2_f32_bf16 v89, v36, s9, v89
    v_dot2_f32_bf16 v90, v37, s8, v90
    v_dot2_f32_bf16 v91, v37, s9, v91
    v_dot2_f32_bf16 v92, v38, s8, v92
    v_dot2_f32_bf16 v93, v38, s9, v93
    v_dot2_f32_bf16 v94, v39, s8, v94
    v_dot2_f32_bf16 v95, v39, s9, v95
    s_waitcnt vmcnt(6)
    v_mov_b32 v107, 0
    buffer_load_dword v106, v107, s[60:63], 0 offen sc1
    v_dot2_f32_bf16 v88, v40, s8, v88
    v_dot2_f32_bf16 v89, v40, s9, v89
    v_dot2_f32_bf16 v90, v41, s8, v90
    v_dot2_f32_bf16 v91, v41, s9, v91
    v_dot2_f32_bf16 v92, v42, s8, v92
    v_dot2_f32_bf16 v93, v42, s9, v93
    v_dot2_f32_bf16 v94, v43, s8, v94
    v_dot2_f32_bf16 v95, v43, s9, v95
    v_dot2_f32_bf16 v88, v44, s8, v88
    v_dot2_f32_bf16 v89, v44, s9, v89
    v_dot2_f32_bf16 v90, v45, s8, v90
    v_dot2_f32_bf16 v91, v45, s9, v91
    v_dot2_f32_bf16 v92, v46, s8, v92
    v_dot2_f32_bf16 v93, v46, s9, v93
    v_dot2_f32_bf16 v94, v47, s8, v94
    v_dot2_f32_bf16 v95, v47, s9, v95
    s_waitcnt vmcnt(5)
    s_nop 0
    v_dot2_f32_bf16 v88, v48, s8, v88
    v_dot2_f32_bf16 v89, v48, s9, v89
    v_dot2_f32_bf16 v90, v49, s8, v90
    v_dot2_f32_bf16 v91, v49, s9, v91
    v_dot2_f32_bf16 v92, v50, s8, v92
    v_dot2_f32_bf16 v93, v50, s9, v93
    v_dot2_f32_bf16 v94, v51, s8, v94
    v_dot2_f32_bf16 v95, v51, s9, v95
    v_dot2_f32_bf16 v88, v52, s8, v88
    v_dot2_f32_bf16 v89, v52, s9, v89
    v_dot2_f32_bf16 v90, v53, s8, v90
    v_dot2_f32_bf16 v91, v53, s9, v91
    v_dot2_f32_bf16 v92, v54, s8, v92
    v_dot2_f32_bf16 v93, v54, s9, v93
    v_dot2_f32_bf16 v94, v55, s8, v94
    v_dot2_f32_bf16 v95, v55, s9, v95
    s_waitcnt vmcnt(3)
    s_nop 0
    v_dot2_f32_bf16 v88, v56, s8, v88
    v_dot2_f32_bf16 v89, v56, s9, v89
    v_dot2_f32_bf16 v90, v57, s8, v90
    v_dot2_f32_bf16 v91, v57, s9, v91
    v_dot2_f32_bf16 v92, v58, s8, v92
    v_dot2_f32_bf16 v93, v58, s9, v93
    v_dot2_f32_bf16 v94, v59, s8, v94
    v_dot2_f32_bf16 v95, v59, s9, v95
    v_dot2_f32_bf16 v88, v60, s8, v88
    v_dot2_f32_bf16 v89, v60, s9, v89
    v_dot2_f32_bf16 v90, v61, s8, v90
    v_dot2_f32_bf16 v91, v61, s9, v91
    v_dot2_f32_bf16 v92, v62, s8, v92
    v_dot2_f32_bf16 v93, v62, s9, v93
    v_dot2_f32_bf16 v94, v63, s8, v94
    v_dot2_f32_bf16 v95, v63, s9, v95
    s_waitcnt vmcnt(1)
    s_nop 0
    v_dot2_f32_bf16 v88, v80, s8, v88
    v_dot2_f32_bf16 v89, v80, s9, v89
    v_dot2_f32_bf16 v90, v81, s8, v90
    v_dot2_f32_bf16 v91, v81, s9, v91
    v_dot2_f32_bf16 v92, v82, s8, v92
    v_dot2_f32_bf16 v93, v82, s9, v93
    v_dot2_f32_bf16 v94, v83, s8, v94
    v_dot2_f32_bf16 v95, v83, s9, v95
    v_dot2_f32_bf16 v88, v84, s8, v88
    v_dot2_f32_bf16 v89, v84, s9, v89
    v_dot2_f32_bf16 v90, v85, s8, v90
    v_dot2_f32_bf16 v91, v85, s9, v91
    v_dot2_f32_bf16 v92, v86, s8, v92
    v_dot2_f32_bf16 v93, v86, s9, v93
    v_dot2_f32_bf16 v94, v87, s8, v94
    v_dot2_f32_bf16 v95, v87, s9, v95
    s_waitcnt vmcnt(0)
    v_readfirstlane_b32 s35, v106
    s_nop 0
    s_cmp_lg_u32 s35, 0
    s_cbranch_scc1 L_gotnq0
L_spinnq0:
    buffer_load_dword v106, v107, s[60:63], 0 offen sc1
    s_waitcnt vmcnt(0)
    v_readfirstlane_b32 s35, v106
    s_nop 1
    s_cmp_lg_u32 s35, 0
    s_cbranch_scc1 L_gotnq0
    s_nop 0
    s_add_u32 s31, s31, 1
    s_cmp_lt_u32 s31, 0x8000
    s_cbranch_scc1 L_spinnq0
L_gotnq0:
    v_permlane32_swap_b32 v88, v92
    v_permlane32_swap_b32 v89, v93
    v_permlane32_swap_b32 v90, v94
    v_permlane32_swap_b32 v91, v95
    v_add_f32 v88, v88, v92
    v_add_f32 v89, v89, v93
    v_add_f32 v90, v90, v94
    v_add_f32 v91, v91, v95
    s_nop 0
    v_permlane16_swap_b32 v88, v90
    v_permlane16_swap_b32 v89, v91
    v_add_f32 v88, v88, v90
    v_add_f32 v89, v89, v91
    s_nop 0
    v_add_f32_dpp v88, v88, v88 row_ror:8 row_mask:0xf bank_mask:0xf
    v_add_f32_dpp v89, v89, v89 row_ror:8 row_mask:0xf bank_mask:0xf
    v_and_b32 v90, 8, v0
    v_cmp_ne_u32 vcc, 0, v90
    s_nop 1
    v_cndmask_b32 v88, v88, v89, vcc
    v_cvt_pk_bf16_f32 v89, v88, v88
    v_and_b32 v89, s3, v89
    v_sub_f32 v89, v88, v89
    v_cvt_pk_bf16_f32 v88, v89, v88
    v_and_b32 v89, 7, v0
    v_lshlrev_b32 v89, 3, v89
    v_lshrrev_b32 v90, 3, v0
    v_add_u32 v89, v89, v90
    v_lshlrev_b32 v89, 4, v89
    s_lshr_b32 s8, s0, 2
    s_lshl_b32 s8, s8, 10
    s_and_b32 s9, s0, 3
    s_lshl_b32 s9, s9, 2
    s_add_u32 s8, s8, s9
    s_add_u32 s8, s8, 12058624
    buffer_store_dword v88, v89, s[64:67], s8 offen sc1
L_nocs:
    v_add_u32 v125, 4480, v124
    v_add_u32 v126, 8960, v124
    v_add_u32 v127, 13440, v124
    s_mul_i32 s8, s4, 21504
    s_add_u32 s13, s13, s8
    s_add_u32 m0, s32, 0
    s_mov_b64 exec, s[14:15]
    buffer_load_dwordx4 v124, s[40:43], s13 offen offset:0 lds
    buffer_load_dwordx4 v125, s[40:43], s13 offen offset:896 lds
    s_mov_b64 exec, -1
    s_mov_b64 exec, s[14:15]
    buffer_load_dwordx4 v126, s[40:43], s13 offen offset:1792 lds
    buffer_load_dwordx4 v127, s[40:43], s13 offen offset:2688 lds
    s_mov_b64 exec, -1
    s_add_u32 m0, s33, 0
    s_add_u32 s13, s13, 172032
    buffer_load_dwordx4 v122, s[36:39], s12 offen offset:0 lds
    buffer_load_dwordx4 v123, s[36:39], s12 offen offset:1024 lds
    s_add_u32 s12, s12, 128
    s_mul_i32 s8, s34, 896
    buffer_load_dwordx4 v[96:99], v5, s[36:39], s8 offen
    s_or_b32 s8, s2, s4
    s_cmp_lg_u32 s8, 0
    s_cbranch_scc1 L_nononq
    s_memrealtime s[8:9]
    s_waitcnt lgkmcnt(0)
    s_or_b32 s8, s8, 1
    v_mov_b32 v8, s8
    v_mov_b32 v9, 0
    s_mov_b64 exec, 1
    buffer_store_dword v8, v9, s[60:63], 0 offen sc1
    s_mov_b64 exec, -1
L_nononq:
    s_waitcnt vmcnt(7)
    s_barrier
    s_cmp_lg_u32 s4, 0
    s_cbranch_scc1 L_nocf
    s_lshl_b32 s8, s0, 7
    s_add_u32 s8, s8, 11993088
    v_mov_b32 v88, s35
    v_mov_b32 v89, 0
    s_mov_b64 exec, 1
    buffer_store_dword v88, v89, s[64:67], s8 offen sc1
    s_mov_b64 exec, -1
L_nocf:
    s_add_u32 m0, s32, 45056
    s_mov_b64 exec, s[14:15]
    buffer_load_dwordx4 v124, s[40:43], s13 offen offset:0 lds
    buffer_load_dwordx4 v125, s[40:43], s13 offen offset:896 lds
    s_mov_b64 exec, -1
    s_mov_b64 exec, s[14:15]
    buffer_load_dwordx4 v126, s[40:43], s13 offen offset:1792 lds
    buffer_load_dwordx4 v127, s[40:43], s13 offen offset:2688 lds
    s_mov_b64 exec, -1
    s_add_u32 m0, s33, 45056
    s_add_u32 s13, s13, 172032
    buffer_load_dwordx4 v122, s[36:39], s12 offen offset:0 lds
    buffer_load_dwordx4 v123, s[36:39], s12 offen offset:1024 lds
    s_add_u32 s12, s12, 128
    s_mov_b32 s8, 0x3f803f80
    s_waitcnt vmcnt(6)
    v_dot2_f32_bf16 v104, v96, s8, 0
    v_dot2_f32_bf16 v105, v96, v96, 0
    v_dot2_f32_bf16 v104, v97, s8, v104
    v_dot2_f32_bf16 v105, v97, v97, v105
    v_dot2_f32_bf16 v104, v98, s8, v104
    v_dot2_f32_bf16 v105, v98, v98, v105
    v_dot2_f32_bf16 v104, v99, s8, v104
    v_dot2_f32_bf16 v105, v99, v99, v105
    s_nop 1
    v_add_f32_dpp v104, v104, v104 row_shr:1 row_mask:0xf bank_mask:0xf bound_ctrl:0
    v_add_f32_dpp v105, v105, v105 row_shr:1 row_mask:0xf bank_mask:0xf bound_ctrl:0
    s_nop 0
    v_add_f32_dpp v104, v104, v104 row_shr:2 row_mask:0xf bank_mask:0xf bound_ctrl:0
    v_add_f32_dpp v105, v105, v105 row_shr:2 row_mask:0xf bank_mask:0xf bound_ctrl:0
    s_nop 0
    v_add_f32_dpp v104, v104, v104 row_shr:4 row_mask:0xf bank_mask:0xf bound_ctrl:0
    v_add_f32_dpp v105, v105, v105 row_shr:4 row_mask:0xf bank_mask:0xf bound_ctrl:0
    s_nop 0
    v_add_f32_dpp v104, v104, v104 row_shr:8 row_mask:0xf bank_mask:0xf bound_ctrl:0
    v_add_f32_dpp v105, v105, v105 row_shr:8 row_mask:0xf bank_mask:0xf bound_ctrl:0
    s_nop 0
    v_add_f32_dpp v104, v104, v104 row_bcast:15 row_mask:0xa bank_mask:0xf
    v_add_f32_dpp v105, v105, v105 row_bcast:15 row_mask:0xa bank_mask:0xf
    s_nop 0
    v_add_f32_dpp v104, v104, v104 row_bcast:31 row_mask:0xc bank_mask:0xf
    v_add_f32_dpp v105, v105, v105 row_bcast:31 row_mask:0xc bank_mask:0xf
    v_mul_f32 v104, 0x3b124925, v104
    v_mul_f32 v105, 0x3b124925, v105
    v_fma_f32 v105, -v104, v104, v105
    v_max_f32 v105, 0, v105
    v_cvt_pk_bf16_f32 v104, v104, v104
    v_lshlrev_b32 v104, 16, v104
    v_cvt_pk_bf16_f32 v105, v105, v105
    v_lshlrev_b32 v105, 16, v105
    v_add_f32 v105, 0x3727c5ac, v105
    v_cvt_pk_bf16_f32 v105, v105, v105
    v_lshlrev_b32 v105, 16, v105
    v_sqrt_f32 v105, v105
    s_nop 0
    v_cvt_pk_bf16_f32 v105, v105, v105
    v_lshlrev_b32 v105, 16, v105
    v_rcp_f32 v105, v105
    v_sub_f32 v104, 0, v104
    s_barrier
    ds_read_b128 v[96:99], v112
    ds_read_b64_tr_b16 v[64:65], v116 offset:0
    ds_read_b64_tr_b16 v[66:67], v116 offset:1792
    ds_read_b64_tr_b16 v[68:69], v116 offset:56
    ds_read_b64_tr_b16 v[70:71], v116 offset:1848
    ds_read_b64_tr_b16 v[72:73], v116 offset:112
    ds_read_b64_tr_b16 v[74:75], v116 offset:1904
    ds_read_b64_tr_b16 v[76:77], v116 offset:168
    ds_read_b64_tr_b16 v[78:79], v116 offset:1960
    s_waitcnt lgkmcnt(4)
    v_mfma_f32_32x32x16_bf16 v[0:15], v[64:67], v[96:99], 0
    ds_read_b64_tr_b16 v[80:81], v117 offset:56
    ds_read_b64_tr_b16 v[82:83], v117 offset:1848
    ds_read_b128 v[100:103], v113
    v_mov_b32 v107, 0
    buffer_load_dword v106, v107, s[60:63], 0 offen sc1
    v_mfma_f32_32x32x16_bf16 v[16:31], v[68:71], v[96:99], 0
    ds_read_b64_tr_b16 v[84:85], v117 offset:112
    ds_read_b64_tr_b16 v[86:87], v117 offset:1904
    s_waitcnt lgkmcnt(5)
    v_mfma_f32_32x32x16_bf16 v[32:47], v[72:75], v[96:99], 0
    ds_read_b64_tr_b16 v[88:89], v117 offset:168
    ds_read_b64_tr_b16 v[90:91], v117 offset:1960
    v_mfma_f32_32x32x16_bf16 v[48:63], v[76:79], v[96:99], 0
    ds_read_b64_tr_b16 v[92:93], v117 offset:0
    ds_read_b64_tr_b16 v[94:95], v117 offset:1792
    s_add_u32 m0, s32, 90112
    s_mov_b64 exec, s[14:15]
    buffer_load_dwordx4 v124, s[40:43], s13 offen offset:0 lds
    buffer_load_dwordx4 v125, s[40:43], s13 offen offset:896 lds
    s_mov_b64 exec, -1
    s_waitcnt lgkmcnt(4)
    v_mfma_f32_32x32x16_bf16 v[16:31], v[80:83], v[100:103], v[16:31]
    ds_read_b64_tr_b16 v[64:65], v118 offset:112
    ds_read_b64_tr_b16 v[66:67], v118 offset:1904
    ds_read_b128 v[96:99], v114
    v_mfma_f32_32x32x16_bf16 v[32:47], v[84:87], v[100:103], v[32:47]
    ds_read_b64_tr_b16 v[68:69], v118 offset:168
    ds_read_b64_tr_b16 v[70:71], v118 offset:1960
    s_waitcnt lgkmcnt(5)
    v_mfma_f32_32x32x16_bf16 v[48:63], v[88:91], v[100:103], v[48:63]
    ds_read_b64_tr_b16 v[72:73], v118 offset:0
    ds_read_b64_tr_b16 v[74:75], v118 offset:1792
    s_mov_b64 exec, s[14:15]
    buffer_load_dwordx4 v126, s[40:43], s13 offen offset:1792 lds
    buffer_load_dwordx4 v127, s[40:43], s13 offen offset:2688 lds
    s_mov_b64 exec, -1
    v_mfma_f32_32x32x16_bf16 v[0:15], v[92:95], v[100:103], v[0:15]
    ds_read_b64_tr_b16 v[76:77], v118 offset:56
    ds_read_b64_tr_b16 v[78:79], v118 offset:1848
    s_waitcnt lgkmcnt(4)
    v_mfma_f32_32x32x16_bf16 v[32:47], v[64:67], v[96:99], v[32:47]
    ds_read_b64_tr_b16 v[80:81], v119 offset:168
    ds_read_b64_tr_b16 v[82:83], v119 offset:1960
    ds_read_b128 v[100:103], v115
    v_mfma_f32_32x32x16_bf16 v[48:63], v[68:71], v[96:99], v[48:63]
    ds_read_b64_tr_b16 v[84:85], v119 offset:0
    ds_read_b64_tr_b16 v[86:87], v119 offset:1792
    s_add_u32 m0, s33, 90112
    s_add_u32 s13, s13, 172032
    buffer_load_dwordx4 v122, s[36:39], s12 offen offset:0 lds
    buffer_load_dwordx4 v123, s[36:39], s12 offen offset:1024 lds
    s_add_u32 s12, s12, 128
    s_waitcnt lgkmcnt(5)
    v_mfma_f32_32x32x16_bf16 v[0:15], v[72:75], v[96:99], v[0:15]
    ds_read_b64_tr_b16 v[88:89], v119 offset:56
    ds_read_b64_tr_b16 v[90:91], v119 offset:1848
    v_mfma_f32_32x32x16_bf16 v[16:31], v[76:79], v[96:99], v[16:31]
    ds_read_b64_tr_b16 v[92:93], v119 offset:112
    ds_read_b64_tr_b16 v[94:95], v119 offset:1904
    s_waitcnt lgkmcnt(4)
    v_mfma_f32_32x32x16_bf16 v[48:63], v[80:83], v[100:103], v[48:63]
    v_add_u32 v112, 45056, v112
    v_add_u32 v113, 45056, v113
    v_add_u32 v114, 45056, v114
    v_add_u32 v115, 45056, v115
    v_add_u32 v116, 45056, v116
    v_add_u32 v117, 45056, v117
    v_add_u32 v118, 45056, v118
    v_add_u32 v119, 45056, v119
    s_waitcnt vmcnt(6)
    v_readfirstlane_b32 s35, v106
    s_nop 0
    s_cmp_lg_u32 s35, 0
    s_cbranch_scc1 L_gotnq
L_spinnq:
    buffer_load_dword v106, v107, s[60:63], 0 offen sc1
    s_waitcnt vmcnt(0)
    v_readfirstlane_b32 s35, v106
    s_nop 1
    s_cmp_lg_u32 s35, 0
    s_cbranch_scc1 L_gotnq
    s_nop 0
    s_add_u32 s31, s31, 1
    s_cmp_lt_u32 s31, 0x8000
    s_cbranch_scc1 L_spinnq
L_gotnq:
    v_mov_b32 v106, s35
    v_mov_b32 v107, s35
    s_lshl_b32 s8, s34, 4
    s_add_u32 s8, s8, 11927552
    v_mov_b32 v136, 0
    s_mov_b32 exec_lo, 0
    s_mov_b32 exec_hi, 0x80000000
    buffer_store_dwordx4 v[104:107], v136, s[64:67], s8 offen sc1
    s_mov_b64 exec, -1
    s_waitcnt lgkmcnt(0)
    s_barrier
    ds_read_b64_tr_b16 v[64:65], v116 offset:0
    ds_read_b64_tr_b16 v[66:67], v116 offset:1792
    ds_read_b128 v[96:99], v112
    s_add_u32 m0, s32, 0
    s_mov_b64 exec, s[14:15]
    buffer_load_dwordx4 v124, s[40:43], s13 offen offset:0 lds
    buffer_load_dwordx4 v125, s[40:43], s13 offen offset:896 lds
    s_mov_b64 exec, -1
    v_mfma_f32_32x32x16_bf16 v[0:15], v[84:87], v[100:103], v[0:15]
    ds_read_b64_tr_b16 v[68:69], v116 offset:56
    ds_read_b64_tr_b16 v[70:71], v116 offset:1848
    v_mfma_f32_32x32x16_bf16 v[16:31], v[88:91], v[100:103], v[16:31]
    ds_read_b64_tr_b16 v[72:73], v116 offset:112
    ds_read_b64_tr_b16 v[74:75], v116 offset:1904
    v_mfma_f32_32x32x16_bf16 v[32:47], v[92:95], v[100:103], v[32:47]
    ds_read_b64_tr_b16 v[76:77], v116 offset:168
    ds_read_b64_tr_b16 v[78:79], v116 offset:1960
    s_mov_b64 exec, s[14:15]
    buffer_load_dwordx4 v126, s[40:43], s13 offen offset:1792 lds
    buffer_load_dwordx4 v127, s[40:43], s13 offen offset:2688 lds
    s_mov_b64 exec, -1
    s_waitcnt lgkmcnt(4)
    v_mfma_f32_32x32x16_bf16 v[0:15], v[64:67], v[96:99], v[0:15]
    ds_read_b64_tr_b16 v[80:81], v117 offset:56
    ds_read_b64_tr_b16 v[82:83], v117 offset:1848
    ds_read_b128 v[100:103], v113
    v_mfma_f32_32x32x16_bf16 v[16:31], v[68:71], v[96:99], v[16:31]
    ds_read_b64_tr_b16 v[84:85], v117 offset:112
    ds_read_b64_tr_b16 v[86:87], v117 offset:1904
    s_waitcnt lgkmcnt(5)
    v_mfma_f32_32x32x16_bf16 v[32:47], v[72:75], v[96:99], v[32:47]
    ds_read_b64_tr_b16 v[88:89], v117 offset:168
    ds_read_b64_tr_b16 v[90:91], v117 offset:1960
    s_add_u32 m0, s33, 0
    s_add_u32 s13, s13, 172032
    buffer_load_dwordx4 v122, s[36:39], s12 offen offset:0 lds
    buffer_load_dwordx4 v123, s[36:39], s12 offen offset:1024 lds
    s_add_u32 s12, s12, 128
    v_mfma_f32_32x32x16_bf16 v[48:63], v[76:79], v[96:99], v[48:63]
    ds_read_b64_tr_b16 v[92:93], v117 offset:0
    ds_read_b64_tr_b16 v[94:95], v117 offset:1792
    s_waitcnt lgkmcnt(4)
    v_mfma_f32_32x32x16_bf16 v[16:31], v[80:83], v[100:103], v[16:31]
    ds_read_b64_tr_b16 v[64:65], v118 offset:112
    ds_read_b64_tr_b16 v[66:67], v118 offset:1904
    ds_read_b128 v[96:99], v114
    v_mfma_f32_32x32x16_bf16 v[32:47], v[84:87], v[100:103], v[32:47]
    ds_read_b64_tr_b16 v[68:69], v118 offset:168
    ds_read_b64_tr_b16 v[70:71], v118 offset:1960
    s_waitcnt lgkmcnt(5)
    v_mfma_f32_32x32x16_bf16 v[48:63], v[88:91], v[100:103], v[48:63]
    ds_read_b64_tr_b16 v[72:73], v118 offset:0
    ds_read_b64_tr_b16 v[74:75], v118 offset:1792
    v_mfma_f32_32x32x16_bf16 v[0:15], v[92:95], v[100:103], v[0:15]
    ds_read_b64_tr_b16 v[76:77], v118 offset:56
    ds_read_b64_tr_b16 v[78:79], v118 offset:1848
    s_waitcnt lgkmcnt(4)
    v_mfma_f32_32x32x16_bf16 v[32:47], v[64:67], v[96:99], v[32:47]
    ds_read_b64_tr_b16 v[80:81], v119 offset:168
    ds_read_b64_tr_b16 v[82:83], v119 offset:1960
    ds_read_b128 v[100:103], v115
    v_mfma_f32_32x32x16_bf16 v[48:63], v[68:71], v[96:99], v[48:63]
    ds_read_b64_tr_b16 v[84:85], v119 offset:0
    ds_read_b64_tr_b16 v[86:87], v119 offset:1792
    s_waitcnt lgkmcnt(5)
    v_mfma_f32_32x32x16_bf16 v[0:15], v[72:75], v[96:99], v[0:15]
    ds_read_b64_tr_b16 v[88:89], v119 offset:56
    ds_read_b64_tr_b16 v[90:91], v119 offset:1848
    v_mfma_f32_32x32x16_bf16 v[16:31], v[76:79], v[96:99], v[16:31]
    ds_read_b64_tr_b16 v[92:93], v119 offset:112
    ds_read_b64_tr_b16 v[94:95], v119 offset:1904
    s_waitcnt lgkmcnt(4)
    v_mfma_f32_32x32x16_bf16 v[48:63], v[80:83], v[100:103], v[48:63]
    v_add_u32 v112, 45056, v112
    v_add_u32 v113, 45056, v113
    v_add_u32 v114, 45056, v114
    v_add_u32 v115, 45056, v115
    v_add_u32 v116, 45056, v116
    v_add_u32 v117, 45056, v117
    v_add_u32 v118, 45056, v118
    v_add_u32 v119, 45056, v119
    s_waitcnt lgkmcnt(0)
    s_waitcnt vmcnt(7)
    s_barrier
    ds_read_b64_tr_b16 v[64:65], v116 offset:0
    ds_read_b64_tr_b16 v[66:67], v116 offset:1792
    ds_read_b128 v[96:99], v112
    s_mul_i32 s8, s24, 1568
    s_lshl_b32 s9, s4, 10
    s_add_u32 s8, s8, s9
    s_add_u32 s9, s9, 144384
    s_add_u32 m0, s9, 0
    s_add_u32 s10, s8, 0
    buffer_load_dwordx4 v141, s[44:47], s10 offen lds
    s_add_u32 m0, s9, 8192
    s_add_u32 s10, s8, 8192
    buffer_load_dwordx4 v141, s[44:47], s10 offen lds
    v_mfma_f32_32x32x16_bf16 v[0:15], v[84:87], v[100:103], v[0:15]
    ds_read_b64_tr_b16 v[68:69], v116 offset:56
    ds_read_b64_tr_b16 v[70:71], v116 offset:1848
    v_mfma_f32_32x32x16_bf16 v[16:31], v[88:91], v[100:103], v[16:31]
    ds_read_b64_tr_b16 v[72:73], v116 offset:112
    ds_read_b64_tr_b16 v[74:75], v116 offset:1904
    s_add_u32 m0, s32, 45056
    s_mov_b64 exec, s[14:15]
    buffer_load_dwordx4 v124, s[40:43], s13 offen offset:0 lds
    buffer_load_dwordx4 v125, s[40:43], s13 offen offset:896 lds
    s_mov_b64 exec, -1
    v_mfma_f32_32x32x16_bf16 v[32:47], v[92:95], v[100:103], v[32:47]
    ds_read_b64_tr_b16 v[76:77], v116 offset:168
    ds_read_b64_tr_b16 v[78:79], v116 offset:1960
    s_waitcnt lgkmcnt(4)
    v_mfma_f32_32x32x16_bf16 v[0:15], v[64:67], v[96:99], v[0:15]
    ds_read_b64_tr_b16 v[80:81], v117 offset:56
    ds_read_b64_tr_b16 v[82:83], v117 offset:1848
    ds_read_b128 v[100:103], v113
    v_mfma_f32_32x32x16_bf16 v[16:31], v[68:71], v[96:99], v[16:31]
    ds_read_b64_tr_b16 v[84:85], v117 offset:112
    ds_read_b64_tr_b16 v[86:87], v117 offset:1904
    s_mov_b64 exec, s[14:15]
    buffer_load_dwordx4 v126, s[40:43], s13 offen offset:1792 lds
    buffer_load_dwordx4 v127, s[40:43], s13 offen offset:2688 lds
    s_mov_b64 exec, -1
    s_waitcnt lgkmcnt(5)
    v_mfma_f32_32x32x16_bf16 v[32:47], v[72:75], v[96:99], v[32:47]
    ds_read_b64_tr_b16 v[88:89], v117 offset:168
    ds_read_b64_tr_b16 v[90:91], v117 offset:1960
    v_mfma_f32_32x32x16_bf16 v[48:63], v[76:79], v[96:99], v[48:63]
    ds_read_b64_tr_b16 v[92:93], v117 offset:0
    ds_read_b64_tr_b16 v[94:95], v117 offset:1792
    s_waitcnt lgkmcnt(4)
    v_mfma_f32_32x32x16_bf16 v[16:31], v[80:83], v[100:103], v[16:31]
    ds_read_b64_tr_b16 v[64:65], v118 offset:112
    ds_read_b64_tr_b16 v[66:67], v118 offset:1904
    ds_read_b128 v[96:99], v114
    s_add_u32 m0, s33, 45056
    s_add_u32 s13, s13, 172032
    buffer_load_dwordx4 v122, s[36:39], s12 offen offset:0 lds
    buffer_load_dwordx4 v123, s[36:39], s12 offen offset:1024 lds
    s_add_u32 s12, s12, 128
    v_mfma_f32_32x32x16_bf16 v[32:47], v[84:87], v[100:103], v[32:47]
    ds_read_b64_tr_b16 v[68:69], v118 offset:168
    ds_read_b64_tr_b16 v[70:71], v118 offset:1960
    s_waitcnt lgkmcnt(5)
    v_mfma_f32_32x32x16_bf16 v[48:63], v[88:91], v[100:103], v[48:63]
    ds_read_b64_tr_b16 v[72:73], v118 offset:0
    ds_read_b64_tr_b16 v[74:75], v118 offset:1792
    v_mfma_f32_32x32x16_bf16 v[0:15], v[92:95], v[100:103], v[0:15]
    ds_read_b64_tr_b16 v[76:77], v118 offset:56
    ds_read_b64_tr_b16 v[78:79], v118 offset:1848
    s_waitcnt lgkmcnt(4)
    v_mfma_f32_32x32x16_bf16 v[32:47], v[64:67], v[96:99], v[32:47]
    ds_read_b64_tr_b16 v[80:81], v119 offset:168
    ds_read_b64_tr_b16 v[82:83], v119 offset:1960
    ds_read_b128 v[100:103], v115
    v_mfma_f32_32x32x16_bf16 v[48:63], v[68:71], v[96:99], v[48:63]
    ds_read_b64_tr_b16 v[84:85], v119 offset:0
    ds_read_b64_tr_b16 v[86:87], v119 offset:1792
    s_waitcnt lgkmcnt(5)
    v_mfma_f32_32x32x16_bf16 v[0:15], v[72:75], v[96:99], v[0:15]
    ds_read_b64_tr_b16 v[88:89], v119 offset:56
    ds_read_b64_tr_b16 v[90:91], v119 offset:1848
    v_mfma_f32_32x32x16_bf16 v[16:31], v[76:79], v[96:99], v[16:31]
    ds_read_b64_tr_b16 v[92:93], v119 offset:112
    ds_read_b64_tr_b16 v[94:95], v119 offset:1904
    s_waitcnt lgkmcnt(4)
    v_mfma_f32_32x32x16_bf16 v[48:63], v[80:83], v[100:103], v[48:63]
    v_subrev_u32 v112, 90112, v112
    v_subrev_u32 v113, 90112, v113
    v_subrev_u32 v114, 90112, v114
    v_subrev_u32 v115, 90112, v115
    v_subrev_u32 v116, 90112, v116
    v_subrev_u32 v117, 90112, v117
    v_subrev_u32 v118, 90112, v118
    v_subrev_u32 v119, 90112, v119
    s_waitcnt lgkmcnt(0)
    s_waitcnt vmcnt(8)
    s_barrier
    ds_read_b64_tr_b16 v[64:65], v116 offset:0
    ds_read_b64_tr_b16 v[66:67], v116 offset:1792
    ds_read_b128 v[96:99], v112
    s_add_u32 m0, s32, 90112
    s_mov_b64 exec, s[14:15]
    buffer_load_dwordx4 v124, s[40:43], s13 offen offset:0 lds
    buffer_load_dwordx4 v125, s[40:43], s13 offen offset:896 lds
    s_mov_b64 exec, -1
    v_mfma_f32_32x32x16_bf16 v[0:15], v[84:87], v[100:103], v[0:15]
    ds_read_b64_tr_b16 v[68:69], v116 offset:56
    ds_read_b64_tr_b16 v[70:71], v116 offset:1848
    s_mov_b64 exec, s[14:15]
    buffer_load_dwordx4 v126, s[40:43], s13 offen offset:1792 lds
    buffer_load_dwordx4 v127, s[40:43], s13 offen offset:2688 lds
    s_mov_b64 exec, -1
    v_mfma_f32_32x32x16_bf16 v[16:31], v[88:91], v[100:103], v[16:31]
    ds_read_b64_tr_b16 v[72:73], v116 offset:112
    ds_read_b64_tr_b16 v[74:75], v116 offset:1904
    v_mfma_f32_32x32x16_bf16 v[32:47], v[92:95], v[100:103], v[32:47]
    ds_read_b64_tr_b16 v[76:77], v116 offset:168
    ds_read_b64_tr_b16 v[78:79], v116 offset:1960
    s_waitcnt lgkmcnt(4)
    v_mfma_f32_32x32x16_bf16 v[0:15], v[64:67], v[96:99], v[0:15]
    ds_read_b64_tr_b16 v[80:81], v117 offset:56
    ds_read_b64_tr_b16 v[82:83], v117 offset:1848
    ds_read_b128 v[100:103], v113
    s_add_u32 m0, s33, 90112
    s_add_u32 s13, s13, 172032
    buffer_load_dwordx4 v122, s[36:39], s12 offen offset:0 lds
    buffer_load_dwordx4 v123, s[36:39], s12 offen offset:1024 lds
    s_add_u32 s12, s12, 128
    v_mfma_f32_32x32x16_bf16 v[16:31], v[68:71], v[96:99], v[16:31]
    ds_read_b64_tr_b16 v[84:85], v117 offset:112
    ds_read_b64_tr_b16 v[86:87], v117 offset:1904
    s_waitcnt lgkmcnt(5)
    v_mfma_f32_32x32x16_bf16 v[32:47], v[72:75], v[96:99], v[32:47]
    ds_read_b64_tr_b16 v[88:89], v117 offset:168
    ds_read_b64_tr_b16 v[90:91], v117 offset:1960
    v_mfma_f32_32x32x16_bf16 v[48:63], v[76:79], v[96:99], v[48:63]
    ds_read_b64_tr_b16 v[92:93], v117 offset:0
    ds_read_b64_tr_b16 v[94:95], v117 offset:1792
    s_lshl_b32 s8, s2, 3
    s_add_u32 s8, s8, s4
    s_mul_i32 s9, s8, 896
    s_lshl_b32 s8, s8, 8
    v_lshlrev_b32 v132, 7, v140
    s_mov_b64 exec, 0x7f
    buffer_load_dword a80, v132, s[52:55], s9 offen
    s_mov_b64 exec, 3
    buffer_load_dword a80, v132, s[48:51], s8 offen
    s_mov_b64 exec, -1
    s_waitcnt lgkmcnt(4)
    v_mfma_f32_32x32x16_bf16 v[16:31], v[80:83], v[100:103], v[16:31]
    ds_read_b64_tr_b16 v[64:65], v118 offset:112
    ds_read_b64_tr_b16 v[66:67], v118 offset:1904
    ds_read_b128 v[96:99], v114
    v_mfma_f32_32x32x16_bf16 v[32:47], v[84:87], v[100:103], v[32:47]
    ds_read_b64_tr_b16 v[68:69], v118 offset:168
    ds_read_b64_tr_b16 v[70:71], v118 offset:1960
    s_waitcnt lgkmcnt(5)
    v_mfma_f32_32x32x16_bf16 v[48:63], v[88:91], v[100:103], v[48:63]
    ds_read_b64_tr_b16 v[72:73], v118 offset:0
    ds_read_b64_tr_b16 v[74:75], v118 offset:1792
    v_mfma_f32_32x32x16_bf16 v[0:15], v[92:95], v[100:103], v[0:15]
    ds_read_b64_tr_b16 v[76:77], v118 offset:56
    ds_read_b64_tr_b16 v[78:79], v118 offset:1848
    s_waitcnt lgkmcnt(4)
    v_mfma_f32_32x32x16_bf16 v[32:47], v[64:67], v[96:99], v[32:47]
    ds_read_b64_tr_b16 v[80:81], v119 offset:168
    ds_read_b64_tr_b16 v[82:83], v119 offset:1960
    ds_read_b128 v[100:103], v115
    v_mfma_f32_32x32x16_bf16 v[48:63], v[68:71], v[96:99], v[48:63]
    ds_read_b64_tr_b16 v[84:85], v119 offset:0
    ds_read_b64_tr_b16 v[86:87], v119 offset:1792
    s_waitcnt lgkmcnt(5)
    v_mfma_f32_32x32x16_bf16 v[0:15], v[72:75], v[96:99], v[0:15]
    ds_read_b64_tr_b16 v[88:89], v119 offset:56
    ds_read_b64_tr_b16 v[90:91], v119 offset:1848
    v_mfma_f32_32x32x16_bf16 v[16:31], v[76:79], v[96:99], v[16:31]
    ds_read_b64_tr_b16 v[92:93], v119 offset:112
    ds_read_b64_tr_b16 v[94:95], v119 offset:1904
    s_waitcnt lgkmcnt(4)
    v_mfma_f32_32x32x16_bf16 v[48:63], v[80:83], v[100:103], v[48:63]
    v_add_u32 v112, 45056, v112
    v_add_u32 v113, 45056, v113
    v_add_u32 v114, 45056, v114
    v_add_u32 v115, 45056, v115
    v_add_u32 v116, 45056, v116
    v_add_u32 v117, 45056, v117
    v_add_u32 v118, 45056, v118
    v_add_u32 v119, 45056, v119
    s_waitcnt lgkmcnt(0)
    s_waitcnt vmcnt(8)
    s_barrier
    ds_read_b64_tr_b16 v[64:65], v116 offset:0
    ds_read_b64_tr_b16 v[66:67], v116 offset:1792
    ds_read_b128 v[96:99], v112
    s_add_u32 m0, s32, 0
    s_mov_b64 exec, s[14:15]
    buffer_load_dwordx4 v124, s[40:43], s13 offen offset:0 lds
    buffer_load_dwordx4 v125, s[40:43], s13 offen offset:896 lds
    s_mov_b64 exec, -1
    v_mfma_f32_32x32x16_bf16 v[0:15], v[84:87], v[100:103], v[0:15]
    ds_read_b64_tr_b16 v[68:69], v116 offset:56
    ds_read_b64_tr_b16 v[70:71], v116 offset:1848
    v_mfma_f32_32x32x16_bf16 v[16:31], v[88:91], v[100:103], v[16:31]
    ds_read_b64_tr_b16 v[72:73], v116 offset:112
    ds_read_b64_tr_b16 v[74:75], v116 offset:1904
    v_mfma_f32_32x32x16_bf16 v[32:47], v[92:95], v[100:103], v[32:47]
    ds_read_b64_tr_b16 v[76:77], v116 offset:168
    ds_read_b64_tr_b16 v[78:79], v116 offset:1960
    s_mov_b64 exec, s[14:15]
    buffer_load_dwordx4 v126, s[40:43], s13 offen offset:1792 lds
    buffer_load_dwordx4 v127, s[40:43], s13 offen offset:2688 lds
    s_mov_b64 exec, -1
    s_waitcnt lgkmcnt(4)
    v_mfma_f32_32x32x16_bf16 v[0:15], v[64:67], v[96:99], v[0:15]
    ds_read_b64_tr_b16 v[80:81], v117 offset:56
    ds_read_b64_tr_b16 v[82:83], v117 offset:1848
    ds_read_b128 v[100:103], v113
    v_mfma_f32_32x32x16_bf16 v[16:31], v[68:71], v[96:99], v[16:31]
    ds_read_b64_tr_b16 v[84:85], v117 offset:112
    ds_read_b64_tr_b16 v[86:87], v117 offset:1904
    s_waitcnt lgkmcnt(5)
    v_mfma_f32_32x32x16_bf16 v[32:47], v[72:75], v[96:99], v[32:47]
    ds_read_b64_tr_b16 v[88:89], v117 offset:168
    ds_read_b64_tr_b16 v[90:91], v117 offset:1960
    s_add_u32 m0, s33, 0
    s_add_u32 s13, s13, 172032
    buffer_load_dwordx4 v122, s[36:39], s12 offen offset:0 lds
    buffer_load_dwordx4 v123, s[36:39], s12 offen offset:1024 lds
    s_add_u32 s12, s12, 128
    v_mfma_f32_32x32x16_bf16 v[48:63], v[76:79], v[96:99], v[48:63]
    ds_read_b64_tr_b16 v[92:93], v117 offset:0
    ds_read_b64_tr_b16 v[94:95], v117 offset:1792
    s_waitcnt lgkmcnt(4)
    v_mfma_f32_32x32x16_bf16 v[16:31], v[80:83], v[100:103], v[16:31]
    ds_read_b64_tr_b16 v[64:65], v118 offset:112
    ds_read_b64_tr_b16 v[66:67], v118 offset:1904
    ds_read_b128 v[96:99], v114
    v_mfma_f32_32x32x16_bf16 v[32:47], v[84:87], v[100:103], v[32:47]
    ds_read_b64_tr_b16 v[68:69], v118 offset:168
    ds_read_b64_tr_b16 v[70:71], v118 offset:1960
    s_mul_i32 s8, s69, 6272
    s_add_u32 s8, s8, 144384
    v_lshrrev_b32 v137, 5, v140
    v_lshlrev_b32 v137, 2, v137
    v_bfe_u32 v138, v140, 2, 2
    v_add_u32 v137, v137, v138
    v_mul_u32_u24 v137, 56, v137
    v_add_u32 v137, s8, v137
    v_bfe_u32 v138, v140, 4, 1
    v_lshlrev_b32 v138, 2, v138
    v_and_or_b32 v138, v140, 3, v138
    v_min_u32 v138, 6, v138
    v_lshl_add_u32 v137, v138, 3, v137
    ds_read_b64_tr_b16 a[0:1], v137 offset:0
    ds_read_b64_tr_b16 a[2:3], v137 offset:448
    ds_read_b64_tr_b16 a[4:5], v137 offset:896
    ds_read_b64_tr_b16 a[6:7], v137 offset:1344
    ds_read_b64_tr_b16 a[8:9], v137 offset:1568
    ds_read_b64_tr_b16 a[10:11], v137 offset:2016
    ds_read_b64_tr_b16 a[12:13], v137 offset:2464
    ds_read_b64_tr_b16 a[14:15], v137 offset:2912
    ds_read_b64_tr_b16 a[16:17], v137 offset:3136
    ds_read_b64_tr_b16 a[18:19], v137 offset:3584
    ds_read_b64_tr_b16 a[20:21], v137 offset:4032
    ds_read_b64_tr_b16 a[22:23], v137 offset:4480
    ds_read_b64_tr_b16 a[24:25], v137 offset:4704
    ds_read_b64_tr_b16 a[26:27], v137 offset:5152
    ds_read_b64_tr_b16 a[28:29], v137 offset:5600
    ds_read_b64_tr_b16 a[30:31], v137 offset:6048
    s_waitcnt lgkmcnt(15)
    v_mfma_f32_32x32x16_bf16 v[48:63], v[88:91], v[100:103], v[48:63]
    ds_read_b64_tr_b16 v[72:73], v118 offset:0
    ds_read_b64_tr_b16 v[74:75], v118 offset:1792
    v_mfma_f32_32x32x16_bf16 v[0:15], v[92:95], v[100:103], v[0:15]
    ds_read_b64_tr_b16 v[76:77], v118 offset:56
    ds_read_b64_tr_b16 v[78:79], v118 offset:1848
    v_mfma_f32_32x32x16_bf16 v[32:47], v[64:67], v[96:99], v[32:47]
    ds_read_b64_tr_b16 v[80:81], v119 offset:168
    ds_read_b64_tr_b16 v[82:83], v119 offset:1960
    ds_read_b128 v[100:103], v115
    v_mfma_f32_32x32x16_bf16 v[48:63], v[68:71], v[96:99], v[48:63]
    ds_read_b64_tr_b16 v[84:85], v119 offset:0
    ds_read_b64_tr_b16 v[86:87], v119 offset:1792
    s_waitcnt lgkmcnt(5)
    v_mfma_f32_32x32x16_bf16 v[0:15], v[72:75], v[96:99], v[0:15]
    ds_read_b64_tr_b16 v[88:89], v119 offset:56
    ds_read_b64_tr_b16 v[90:91], v119 offset:1848
    v_mfma_f32_32x32x16_bf16 v[16:31], v[76:79], v[96:99], v[16:31]
    ds_read_b64_tr_b16 v[92:93], v119 offset:112
    ds_read_b64_tr_b16 v[94:95], v119 offset:1904
    s_waitcnt lgkmcnt(4)
    v_mfma_f32_32x32x16_bf16 v[48:63], v[80:83], v[100:103], v[48:63]
    v_add_u32 v112, 45056, v112
    v_add_u32 v113, 45056, v113
    v_add_u32 v114, 45056, v114
    v_add_u32 v115, 45056, v115
    v_add_u32 v116, 45056, v116
    v_add_u32 v117, 45056, v117
    v_add_u32 v118, 45056, v118
    v_add_u32 v119, 45056, v119
    s_waitcnt lgkmcnt(0)
    s_waitcnt vmcnt(8)
    s_barrier
    ds_read_b64_tr_b16 v[64:65], v116 offset:0
    ds_read_b64_tr_b16 v[66:67], v116 offset:1792
    ds_read_b128 v[96:99], v112
    v_mfma_f32_32x32x16_bf16 v[0:15], v[84:87], v[100:103], v[0:15]
    ds_read_b64_tr_b16 v[68:69], v116 offset:56
    ds_read_b64_tr_b16 v[70:71], v116 offset:1848
    v_mfma_f32_32x32x16_bf16 v[16:31], v[88:91], v[100:103], v[16:31]
    ds_read_b64_tr_b16 v[72:73], v116 offset:112
    ds_read_b64_tr_b16 v[74:75], v116 offset:1904
    s_mov_b32 s101, 11993088
    buffer_load_dword v111, v110, s[64:67], s101 offen sc1
    v_mfma_f32_32x32x16_bf16 v[32:47], v[92:95], v[100:103], v[32:47]
    ds_read_b64_tr_b16 v[76:77], v116 offset:168
    ds_read_b64_tr_b16 v[78:79], v116 offset:1960
    s_waitcnt lgkmcnt(4)
    v_mfma_f32_32x32x16_bf16 v[0:15], v[64:67], v[96:99], v[0:15]
    ds_read_b64_tr_b16 v[80:81], v117 offset:56
    ds_read_b64_tr_b16 v[82:83], v117 offset:1848
    ds_read_b128 v[100:103], v113
    v_mfma_f32_32x32x16_bf16 v[16:31], v[68:71], v[96:99], v[16:31]
    ds_read_b64_tr_b16 v[84:85], v117 offset:112
    ds_read_b64_tr_b16 v[86:87], v117 offset:1904
    s_waitcnt lgkmcnt(5)
    v_mfma_f32_32x32x16_bf16 v[32:47], v[72:75], v[96:99], v[32:47]
    ds_read_b64_tr_b16 v[88:89], v117 offset:168
    ds_read_b64_tr_b16 v[90:91], v117 offset:1960
    v_mfma_f32_32x32x16_bf16 v[48:63], v[76:79], v[96:99], v[48:63]
    ds_read_b64_tr_b16 v[92:93], v117 offset:0
    ds_read_b64_tr_b16 v[94:95], v117 offset:1792
    s_waitcnt lgkmcnt(4)
    v_mfma_f32_32x32x16_bf16 v[16:31], v[80:83], v[100:103], v[16:31]
    ds_read_b64_tr_b16 v[64:65], v118 offset:112
    ds_read_b64_tr_b16 v[66:67], v118 offset:1904
    ds_read_b128 v[96:99], v114
    v_mfma_f32_32x32x16_bf16 v[32:47], v[84:87], v[100:103], v[32:47]
    ds_read_b64_tr_b16 v[68:69], v118 offset:168
    ds_read_b64_tr_b16 v[70:71], v118 offset:1960
    s_waitcnt lgkmcnt(5)
    v_mfma_f32_32x32x16_bf16 v[48:63], v[88:91], v[100:103], v[48:63]
    ds_read_b64_tr_b16 v[72:73], v118 offset:0
    ds_read_b64_tr_b16 v[74:75], v118 offset:1792
    v_mfma_f32_32x32x16_bf16 v[0:15], v[92:95], v[100:103], v[0:15]
    ds_read_b64_tr_b16 v[76:77], v118 offset:56
    ds_read_b64_tr_b16 v[78:79], v118 offset:1848
    s_waitcnt lgkmcnt(4)
    v_mfma_f32_32x32x16_bf16 v[32:47], v[64:67], v[96:99], v[32:47]
    ds_read_b64_tr_b16 v[80:81], v119 offset:168
    ds_read_b64_tr_b16 v[82:83], v119 offset:1960
    ds_read_b128 v[100:103], v115
    v_mfma_f32_32x32x16_bf16 v[48:63], v[68:71], v[96:99], v[48:63]
    ds_read_b64_tr_b16 v[84:85], v119 offset:0
    ds_read_b64_tr_b16 v[86:87], v119 offset:1792
    s_waitcnt lgkmcnt(5)
    v_mfma_f32_32x32x16_bf16 v[0:15], v[72:75], v[96:99], v[0:15]
    ds_read_b64_tr_b16 v[88:89], v119 offset:56
    ds_read_b64_tr_b16 v[90:91], v119 offset:1848
    v_mfma_f32_32x32x16_bf16 v[16:31], v[76:79], v[96:99], v[16:31]
    ds_read_b64_tr_b16 v[92:93], v119 offset:112
    ds_read_b64_tr_b16 v[94:95], v119 offset:1904
    s_waitcnt lgkmcnt(4)
    v_mfma_f32_32x32x16_bf16 v[48:63], v[80:83], v[100:103], v[48:63]
    v_subrev_u32 v112, 90112, v112
    v_subrev_u32 v113, 90112, v113
    v_subrev_u32 v114, 90112, v114
    v_subrev_u32 v115, 90112, v115
    v_subrev_u32 v116, 90112, v116
    v_subrev_u32 v117, 90112, v117
    v_subrev_u32 v118, 90112, v118
    v_subrev_u32 v119, 90112, v119
    s_waitcnt vmcnt(0)
    v_cmp_ne_u32 vcc, s35, v111
    s_nop 1
    s_cbranch_vccz L_polldcq
L_pollcq:
    buffer_load_dword v111, v110, s[64:67], s101 offen sc1
    s_waitcnt vmcnt(0)
    v_cmp_ne_u32 vcc, s35, v111
    s_nop 1
    s_cbranch_vccz L_polldcq
    s_nop 0
    s_add_u32 s31, s31, 1
    s_cmp_lt_u32 s31, 0x8000
    s_cbranch_scc1 L_pollcq
L_polldcq:
    s_lshl_b32 s8, s6, 2
    s_add_u32 s8, s8, s68
    s_lshl_b32 s8, s8, 9
    s_add_u32 s34, s8, 11927552
    v_and_b32 v122, 31, v140
    v_lshlrev_b32 v122, 4, v122
    buffer_load_dwordx4 v[104:107], v122, s[64:67], s34 offen sc1
    s_waitcnt lgkmcnt(0)
    s_barrier
    ds_read_b64_tr_b16 v[64:65], v116 offset:0
    ds_read_b64_tr_b16 v[66:67], v116 offset:1792
    ds_read_b128 v[96:99], v112
    v_mfma_f32_32x32x16_bf16 v[0:15], v[84:87], v[100:103], v[0:15]
    ds_read_b64_tr_b16 v[68:69], v116 offset:56
    ds_read_b64_tr_b16 v[70:71], v116 offset:1848
    buffer_load_dwordx4 a[32:35], v108, s[64:67], s30 offen offset:0 sc1
    buffer_load_dwordx4 a[36:39], v108, s[64:67], s30 offen offset:448 sc1
    buffer_load_dwordx4 a[40:43], v108, s[64:67], s30 offen offset:896 sc1
    buffer_load_dwordx4 a[44:47], v108, s[64:67], s30 offen offset:1344 sc1
    v_mfma_f32_32x32x16_bf16 v[16:31], v[88:91], v[100:103], v[16:31]
    ds_read_b64_tr_b16 v[72:73], v116 offset:112
    ds_read_b64_tr_b16 v[74:75], v116 offset:1904
    v_mfma_f32_32x32x16_bf16 v[32:47], v[92:95], v[100:103], v[32:47]
    ds_read_b64_tr_b16 v[76:77], v116 offset:168
    ds_read_b64_tr_b16 v[78:79], v116 offset:1960
    s_waitcnt lgkmcnt(4)
    v_mfma_f32_32x32x16_bf16 v[0:15], v[64:67], v[96:99], v[0:15]
    ds_read_b64_tr_b16 v[80:81], v117 offset:56
    ds_read_b64_tr_b16 v[82:83], v117 offset:1848
    ds_read_b128 v[100:103], v113
    v_mfma_f32_32x32x16_bf16 v[16:31], v[68:71], v[96:99], v[16:31]
    ds_read_b64_tr_b16 v[84:85], v117 offset:112
    ds_read_b64_tr_b16 v[86:87], v117 offset:1904
    s_waitcnt lgkmcnt(5)
    v_mfma_f32_32x32x16_bf16 v[32:47], v[72:75], v[96:99], v[32:47]
    ds_read_b64_tr_b16 v[88:89], v117 offset:168
    ds_read_b64_tr_b16 v[90:91], v117 offset:1960
    v_mfma_f32_32x32x16_bf16 v[48:63], v[76:79], v[96:99], v[48:63]
    ds_read_b64_tr_b16 v[92:93], v117 offset:0
    ds_read_b64_tr_b16 v[94:95], v117 offset:1792
    s_waitcnt lgkmcnt(4)
    v_mfma_f32_32x32x16_bf16 v[16:31], v[80:83], v[100:103], v[16:31]
    ds_read_b64_tr_b16 v[64:65], v118 offset:112
    ds_read_b64_tr_b16 v[66:67], v118 offset:1904
    ds_read_b128 v[96:99], v114
    v_mfma_f32_32x32x16_bf16 v[32:47], v[84:87], v[100:103], v[32:47]
    ds_read_b64_tr_b16 v[68:69], v118 offset:168
    ds_read_b64_tr_b16 v[70:71], v118 offset:1960
    s_waitcnt lgkmcnt(5)
    v_mfma_f32_32x32x16_bf16 v[48:63], v[88:91], v[100:103], v[48:63]
    ds_read_b64_tr_b16 v[72:73], v118 offset:0
    ds_read_b64_tr_b16 v[74:75], v118 offset:1792
    v_mfma_f32_32x32x16_bf16 v[0:15], v[92:95], v[100:103], v[0:15]
    ds_read_b64_tr_b16 v[76:77], v118 offset:56
    ds_read_b64_tr_b16 v[78:79], v118 offset:1848
    s_waitcnt lgkmcnt(4)
    v_mfma_f32_32x32x16_bf16 v[32:47], v[64:67], v[96:99], v[32:47]
    ds_read_b64_tr_b16 v[80:81], v119 offset:168
    ds_read_b64_tr_b16 v[82:83], v119 offset:1960
    ds_read_b128 v[100:103], v115
    v_mfma_f32_32x32x16_bf16 v[48:63], v[68:71], v[96:99], v[48:63]
    ds_read_b64_tr_b16 v[84:85], v119 offset:0
    ds_read_b64_tr_b16 v[86:87], v119 offset:1792
    s_waitcnt lgkmcnt(5)
    v_mfma_f32_32x32x16_bf16 v[0:15], v[72:75], v[96:99], v[0:15]
    ds_read_b64_tr_b16 v[88:89], v119 offset:56
    ds_read_b64_tr_b16 v[90:91], v119 offset:1848
    v_mfma_f32_32x32x16_bf16 v[16:31], v[76:79], v[96:99], v[16:31]
    ds_read_b64_tr_b16 v[92:93], v119 offset:112
    ds_read_b64_tr_b16 v[94:95], v119 offset:1904
    s_waitcnt lgkmcnt(4)
    v_mfma_f32_32x32x16_bf16 v[48:63], v[80:83], v[100:103], v[48:63]
    v_mfma_f32_32x32x16_bf16 v[0:15], v[84:87], v[100:103], v[0:15]
    s_waitcnt lgkmcnt(0)
    v_mfma_f32_32x32x16_bf16 v[16:31], v[88:91], v[100:103], v[16:31]
    v_mfma_f32_32x32x16_bf16 v[32:47], v[92:95], v[100:103], v[32:47]
    s_waitcnt vmcnt(4)
    v_cmp_ne_u32 vcc, s35, v106
    s_nop 1
    s_cbranch_vccz L_gotrq
L_spinrq:
    buffer_load_dwordx4 v[104:107], v122, s[64:67], s34 offen sc1
    s_waitcnt vmcnt(0)
    v_cmp_ne_u32 vcc, s35, v106
    s_nop 1
    s_cbranch_vccz L_gotrq
    s_nop 0
    s_add_u32 s31, s31, 1
    s_cmp_lt_u32 s31, 0x8000
    s_cbranch_scc1 L_spinrq
L_gotrq:
    v_cvt_pk_bf16_f32 v96, v104, v104
    v_cvt_pk_bf16_f32 v97, v104, v104
    v_cvt_pk_bf16_f32 v98, v104, v104
    v_cvt_pk_bf16_f32 v99, v104, v104
    v_mul_f32 v104, 0x3fb8aa3b, v105
    s_waitcnt vmcnt(3)
    v_mfma_f32_32x32x16_bf16 v[0:15], a[32:35], v[96:99], v[0:15]
    s_waitcnt vmcnt(2)
    v_mfma_f32_32x32x16_bf16 v[16:31], a[36:39], v[96:99], v[16:31]
    s_waitcnt vmcnt(1)
    v_mfma_f32_32x32x16_bf16 v[32:47], a[40:43], v[96:99], v[32:47]
    s_waitcnt vmcnt(0)
    v_mfma_f32_32x32x16_bf16 v[48:63], a[44:47], v[96:99], v[48:63]
    s_barrier
    s_nop 4
    v_cvt_pk_bf16_f32 v80, v0, v1
    v_cvt_pk_bf16_f32 v81, v2, v3
    v_cvt_pk_bf16_f32 v82, v4, v5
    v_cvt_pk_bf16_f32 v83, v6, v7
    v_cvt_pk_bf16_f32 v84, v8, v9
    v_cvt_pk_bf16_f32 v85, v10, v11
    v_cvt_pk_bf16_f32 v86, v12, v13
    v_cvt_pk_bf16_f32 v87, v14, v15
    v_cndmask_b32 v86, v86, 0, s[28:29]
    v_cndmask_b32 v87, v87, 0, s[28:29]
    v_mfma_f32_32x32x16_bf16 v[0:15], a[0:3], v[80:83], 0
    s_nop 0
    v_mfma_f32_32x32x16_bf16 v[0:15], a[4:7], v[84:87], v[0:15]
    s_nop 0
    v_cvt_pk_bf16_f32 v88, v16, v17
    v_cvt_pk_bf16_f32 v89, v18, v19
    v_cvt_pk_bf16_f32 v90, v20, v21
    v_cvt_pk_bf16_f32 v91, v22, v23
    v_cvt_pk_bf16_f32 v92, v24, v25
    v_cvt_pk_bf16_f32 v93, v26, v27
    v_cvt_pk_bf16_f32 v94, v28, v29
    v_cvt_pk_bf16_f32 v95, v30, v31
    v_cndmask_b32 v94, v94, 0, s[28:29]
    v_cndmask_b32 v95, v95, 0, s[28:29]
    v_mfma_f32_32x32x16_bf16 v[16:31], a[8:11], v[88:91], 0
    s_nop 0
    v_mfma_f32_32x32x16_bf16 v[16:31], a[12:15], v[92:95], v[16:31]
    s_nop 0
    v_cvt_pk_bf16_f32 v80, v32, v33
    v_cvt_pk_bf16_f32 v81, v34, v35
    v_cvt_pk_bf16_f32 v82, v36, v37
    v_cvt_pk_bf16_f32 v83, v38, v39
    v_cvt_pk_bf16_f32 v84, v40, v41
    v_cvt_pk_bf16_f32 v85, v42, v43
    v_cvt_pk_bf16_f32 v86, v44, v45
    v_cvt_pk_bf16_f32 v87, v46, v47
    v_cndmask_b32 v86, v86, 0, s[28:29]
    v_cndmask_b32 v87, v87, 0, s[28:29]
    v_mfma_f32_32x32x16_bf16 v[32:47], a[16:19], v[80:83], 0
    s_nop 0
    v_mfma_f32_32x32x16_bf16 v[32:47], a[20:23], v[84:87], v[32:47]
    s_nop 0
    v_cvt_pk_bf16_f32 v88, v48, v49
    v_cvt_pk_bf16_f32 v89, v50, v51
    v_cvt_pk_bf16_f32 v90, v52, v53
    v_cvt_pk_bf16_f32 v91, v54, v55
    v_cvt_pk_bf16_f32 v92, v56, v57
    v_cvt_pk_bf16_f32 v93, v58, v59
    v_cvt_pk_bf16_f32 v94, v60, v61
    v_cvt_pk_bf16_f32 v95, v62, v63
    v_cndmask_b32 v94, v94, 0, s[28:29]
    v_cndmask_b32 v95, v95, 0, s[28:29]
    v_mfma_f32_32x32x16_bf16 v[48:63], a[24:27], v[88:91], 0
    s_nop 0
    v_mfma_f32_32x32x16_bf16 v[48:63], a[28:31], v[92:95], v[48:63]
    s_nop 0
    v_mov_b32 v138, 0xff800000
    v_max3_f32 v128, v0, v1, v2
    v_max3_f32 v129, -v0, -v1, -v2
    v_max3_f32 v134, v8, v9, v10
    v_max3_f32 v135, -v8, -v9, -v10
    v_max3_f32 v128, v128, v3, v4
    v_max3_f32 v129, v129, -v3, -v4
    v_max3_f32 v134, v134, v11, v12
    v_max3_f32 v135, v135, -v11, -v12
    v_max3_f32 v128, v128, v5, v6
    v_max3_f32 v129, v129, -v5, -v6
    v_max3_f32 v134, v134, v13, v14
    v_max3_f32 v135, v135, -v13, -v14
    v_max3_f32 v134, v134, v7, v15
    v_max3_f32 v135, v135, -v7, -v15
    v_max_f32 v128, v128, v134
    v_max_f32 v129, v129, v135
    s_nop 1
    v_permlane32_swap_b32 v128, v129
    v_max_f32 v130, v128, v129
    v_mul_f32 v130, -v104, v130
    v_mov_b32 v132, v130
    s_nop 1
    v_permlane32_swap_b32 v130, v132
    v_cndmask_b32 v131, v130, v138, s[28:29]
    v_cndmask_b32 v133, v132, v138, s[28:29]
    v_pk_fma_f32 v[64:65], v[0:1], v[104:105], v[130:131] op_sel_hi:[1,0,0]
    v_pk_fma_f32 v[80:81], v[0:1], v[104:105], v[132:133] op_sel_hi:[1,0,0] neg_lo:[1,0,0] neg_hi:[1,0,0]
    v_pk_fma_f32 v[66:67], v[2:3], v[104:105], v[130:131] op_sel_hi:[1,0,0]
    v_pk_fma_f32 v[82:83], v[2:3], v[104:105], v[132:133] op_sel_hi:[1,0,0] neg_lo:[1,0,0] neg_hi:[1,0,0]
    v_pk_fma_f32 v[68:69], v[4:5], v[104:105], v[130:131] op_sel_hi:[1,0,0]
    v_pk_fma_f32 v[84:85], v[4:5], v[104:105], v[132:133] op_sel_hi:[1,0,0] neg_lo:[1,0,0] neg_hi:[1,0,0]
    v_pk_fma_f32 v[70:71], v[6:7], v[104:105], v[130:131] op_sel_hi:[1,0,0]
    v_pk_fma_f32 v[86:87], v[6:7], v[104:105], v[132:133] op_sel_hi:[1,0,0] neg_lo:[1,0,0] neg_hi:[1,0,0]
    v_pk_fma_f32 v[72:73], v[8:9], v[104:105], v[130:131] op_sel_hi:[1,0,0]
    v_pk_fma_f32 v[88:89], v[8:9], v[104:105], v[132:133] op_sel_hi:[1,0,0] neg_lo:[1,0,0] neg_hi:[1,0,0]
    v_pk_fma_f32 v[74:75], v[10:11], v[104:105], v[130:131] op_sel_hi:[1,0,0]
    v_pk_fma_f32 v[90:91], v[10:11], v[104:105], v[132:133] op_sel_hi:[1,0,0] neg_lo:[1,0,0] neg_hi:[1,0,0]
    v_pk_fma_f32 v[76:77], v[12:13], v[104:105], v[130:131] op_sel:[0,0,1] op_sel_hi:[1,0,1]
    v_pk_fma_f32 v[92:93], v[12:13], v[104:105], v[132:133] op_sel:[0,0,1] op_sel_hi:[1,0,1] neg_lo:[1,0,0] neg_hi:[1,0,0]
    v_pk_fma_f32 v[78:79], v[14:15], v[104:105], v[130:131] op_sel:[0,0,1] op_sel_hi:[1,0,1]
    v_pk_fma_f32 v[94:95], v[14:15], v[104:105], v[132:133] op_sel:[0,0,1] op_sel_hi:[1,0,1] neg_lo:[1,0,0] neg_hi:[1,0,0]
    v_exp_f32 v64, v64
    v_exp_f32 v80, v80
    v_exp_f32 v65, v65
    v_exp_f32 v81, v81
    v_exp_f32 v66, v66
    v_exp_f32 v82, v82
    v_exp_f32 v67, v67
    v_exp_f32 v83, v83
    v_exp_f32 v68, v68
    v_exp_f32 v84, v84
    v_exp_f32 v69, v69
    v_exp_f32 v85, v85
    v_exp_f32 v70, v70
    v_exp_f32 v86, v86
    v_exp_f32 v71, v71
    v_exp_f32 v87, v87
    v_exp_f32 v72, v72
    v_exp_f32 v88, v88
    v_exp_f32 v73, v73
    v_exp_f32 v89, v89
    v_exp_f32 v74, v74
    v_exp_f32 v90, v90
    v_exp_f32 v75, v75
    v_exp_f32 v91, v91
    v_exp_f32 v76, v76
    v_exp_f32 v92, v92
    v_exp_f32 v77, v77
    v_exp_f32 v93, v93
    v_exp_f32 v78, v78
    v_exp_f32 v94, v94
    v_exp_f32 v79, v79
    v_exp_f32 v95, v95
    v_pk_add_f32 v[134:135], v[64:65], v[66:67]
    v_pk_add_f32 v[136:137], v[80:81], v[82:83]
    v_pk_add_f32 v[134:135], v[134:135], v[68:69]
    v_pk_add_f32 v[136:137], v[136:137], v[84:85]
    v_pk_add_f32 v[134:135], v[134:135], v[70:71]
    v_pk_add_f32 v[136:137], v[136:137], v[86:87]
    v_pk_add_f32 v[134:135], v[134:135], v[72:73]
    v_pk_add_f32 v[136:137], v[136:137], v[88:89]
    v_pk_add_f32 v[134:135], v[134:135], v[74:75]
    v_pk_add_f32 v[136:137], v[136:137], v[90:91]
    v_pk_add_f32 v[134:135], v[134:135], v[76:77]
    v_pk_add_f32 v[136:137], v[136:137], v[92:93]
    v_pk_add_f32 v[134:135], v[134:135], v[78:79]
    v_pk_add_f32 v[136:137], v[136:137], v[94:95]
    v_add_f32 v134, v134, v135
    v_add_f32 v136, v136, v137
    s_nop 1
    v_permlane32_swap_b32 v134, v136
    v_add_f32 v130, v134, v136
    v_mov_b32 v132, v130
    v_cvt_pk_bf16_f32 v0, v64, v65
    v_cvt_pk_bf16_f32 v1, v66, v67
    v_permlane32_swap_b32 v130, v132
    v_rcp_f32 v132, v132
    v_cvt_pk_bf16_f32 v2, v68, v69
    v_cvt_pk_bf16_f32 v3, v70, v71
    v_cvt_pk_bf16_f32 v4, v72, v73
    v_cvt_pk_bf16_f32 v5, v74, v75
    v_cvt_pk_bf16_f32 v6, v76, v77
    v_cvt_pk_bf16_f32 v7, v78, v79
    v_mul_f32 v132, v132, v130
    v_mov_b32 v124, v130
    v_pk_mul_f32 v[80:81], v[80:81], v[132:133] op_sel_hi:[1,0]
    v_pk_mul_f32 v[82:83], v[82:83], v[132:133] op_sel_hi:[1,0]
    v_pk_mul_f32 v[84:85], v[84:85], v[132:133] op_sel_hi:[1,0]
    v_pk_mul_f32 v[86:87], v[86:87], v[132:133] op_sel_hi:[1,0]
    v_pk_mul_f32 v[88:89], v[88:89], v[132:133] op_sel_hi:[1,0]
    v_pk_mul_f32 v[90:91], v[90:91], v[132:133] op_sel_hi:[1,0]
    v_pk_mul_f32 v[92:93], v[92:93], v[132:133] op_sel_hi:[1,0]
    v_pk_mul_f32 v[94:95], v[94:95], v[132:133] op_sel_hi:[1,0]
    v_cvt_pk_bf16_f32 v8, v80, v81
    v_cvt_pk_bf16_f32 v9, v82, v83
    v_cvt_pk_bf16_f32 v10, v84, v85
    v_cvt_pk_bf16_f32 v11, v86, v87
    v_cvt_pk_bf16_f32 v12, v88, v89
    v_cvt_pk_bf16_f32 v13, v90, v91
    v_cvt_pk_bf16_f32 v14, v92, v93
    v_cvt_pk_bf16_f32 v15, v94, v95
    v_mov_b32 v138, 0xff800000
    v_max3_f32 v128, v16, v17, v18
    v_max3_f32 v129, -v16, -v17, -v18
    v_max3_f32 v134, v24, v25, v26
    v_max3_f32 v135, -v24, -v25, -v26
    v_max3_f32 v128, v128, v19, v20
    v_max3_f32 v129, v129, -v19, -v20
    v_max3_f32 v134, v134, v27, v28
    v_max3_f32 v135, v135, -v27, -v28
    v_max3_f32 v128, v128, v21, v22
    v_max3_f32 v129, v129, -v21, -v22
    v_max3_f32 v134, v134, v29, v30
    v_max3_f32 v135, v135, -v29, -v30
    v_max3_f32 v134, v134, v23, v31
    v_max3_f32 v135, v135, -v23, -v31
    v_max_f32 v128, v128, v134
    v_max_f32 v129, v129, v135
    s_nop 1
    v_permlane32_swap_b32 v128, v129
    v_max_f32 v130, v128, v129
    v_mul_f32 v130, -v104, v130
    v_mov_b32 v132, v130
    s_nop 1
    v_permlane32_swap_b32 v130, v132
    v_cndmask_b32 v131, v130, v138, s[28:29]
    v_cndmask_b32 v133, v132, v138, s[28:29]
    v_pk_fma_f32 v[64:65], v[16:17], v[104:105], v[130:131] op_sel_hi:[1,0,0]
    v_pk_fma_f32 v[80:81], v[16:17], v[104:105], v[132:133] op_sel_hi:[1,0,0] neg_lo:[1,0,0] neg_hi:[1,0,0]
    v_pk_fma_f32 v[66:67], v[18:19], v[104:105], v[130:131] op_sel_hi:[1,0,0]
    v_pk_fma_f32 v[82:83], v[18:19], v[104:105], v[132:133] op_sel_hi:[1,0,0] neg_lo:[1,0,0] neg_hi:[1,0,0]
    v_pk_fma_f32 v[68:69], v[20:21], v[104:105], v[130:131] op_sel_hi:[1,0,0]
    v_pk_fma_f32 v[84:85], v[20:21], v[104:105], v[132:133] op_sel_hi:[1,0,0] neg_lo:[1,0,0] neg_hi:[1,0,0]
    v_pk_fma_f32 v[70:71], v[22:23], v[104:105], v[130:131] op_sel_hi:[1,0,0]
    v_pk_fma_f32 v[86:87], v[22:23], v[104:105], v[132:133] op_sel_hi:[1,0,0] neg_lo:[1,0,0] neg_hi:[1,0,0]
    v_pk_fma_f32 v[72:73], v[24:25], v[104:105], v[130:131] op_sel_hi:[1,0,0]
    v_pk_fma_f32 v[88:89], v[24:25], v[104:105], v[132:133] op_sel_hi:[1,0,0] neg_lo:[1,0,0] neg_hi:[1,0,0]
    v_pk_fma_f32 v[74:75], v[26:27], v[104:105], v[130:131] op_sel_hi:[1,0,0]
    v_pk_fma_f32 v[90:91], v[26:27], v[104:105], v[132:133] op_sel_hi:[1,0,0] neg_lo:[1,0,0] neg_hi:[1,0,0]
    v_pk_fma_f32 v[76:77], v[28:29], v[104:105], v[130:131] op_sel:[0,0,1] op_sel_hi:[1,0,1]
    v_pk_fma_f32 v[92:93], v[28:29], v[104:105], v[132:133] op_sel:[0,0,1] op_sel_hi:[1,0,1] neg_lo:[1,0,0] neg_hi:[1,0,0]
    v_pk_fma_f32 v[78:79], v[30:31], v[104:105], v[130:131] op_sel:[0,0,1] op_sel_hi:[1,0,1]
    v_pk_fma_f32 v[94:95], v[30:31], v[104:105], v[132:133] op_sel:[0,0,1] op_sel_hi:[1,0,1] neg_lo:[1,0,0] neg_hi:[1,0,0]
    v_exp_f32 v64, v64
    v_exp_f32 v80, v80
    v_exp_f32 v65, v65
    v_exp_f32 v81, v81
    v_exp_f32 v66, v66
    v_exp_f32 v82, v82
    v_exp_f32 v67, v67
    v_exp_f32 v83, v83
    v_exp_f32 v68, v68
    v_exp_f32 v84, v84
    v_exp_f32 v69, v69
    v_exp_f32 v85, v85
    v_exp_f32 v70, v70
    v_exp_f32 v86, v86
    v_exp_f32 v71, v71
    v_exp_f32 v87, v87
    v_exp_f32 v72, v72
    v_exp_f32 v88, v88
    v_exp_f32 v73, v73
    v_exp_f32 v89, v89
    v_exp_f32 v74, v74
    v_exp_f32 v90, v90
    v_exp_f32 v75, v75
    v_exp_f32 v91, v91
    v_exp_f32 v76, v76
    v_exp_f32 v92, v92
    v_exp_f32 v77, v77
    v_exp_f32 v93, v93
    v_exp_f32 v78, v78
    v_exp_f32 v94, v94
    v_exp_f32 v79, v79
    v_exp_f32 v95, v95
    v_pk_add_f32 v[134:135], v[64:65], v[66:67]
    v_pk_add_f32 v[136:137], v[80:81], v[82:83]
    v_pk_add_f32 v[134:135], v[134:135], v[68:69]
    v_pk_add_f32 v[136:137], v[136:137], v[84:85]
    v_pk_add_f32 v[134:135], v[134:135], v[70:71]
    v_pk_add_f32 v[136:137], v[136:137], v[86:87]
    v_pk_add_f32 v[134:135], v[134:135], v[72:73]
    v_pk_add_f32 v[136:137], v[136:137], v[88:89]
    v_pk_add_f32 v[134:135], v[134:135], v[74:75]
    v_pk_add_f32 v[136:137], v[136:137], v[90:91]
    v_pk_add_f32 v[134:135], v[134:135], v[76:77]
    v_pk_add_f32 v[136:137], v[136:137], v[92:93]
    v_pk_add_f32 v[134:135], v[134:135], v[78:79]
    v_pk_add_f32 v[136:137], v[136:137], v[94:95]
    v_add_f32 v134, v134, v135
    v_add_f32 v136, v136, v137
    s_nop 1
    v_permlane32_swap_b32 v134, v136
    v_add_f32 v130, v134, v136
    v_mov_b32 v132, v130
    v_cvt_pk_bf16_f32 v16, v64, v65
    v_cvt_pk_bf16_f32 v17, v66, v67
    v_permlane32_swap_b32 v130, v132
    v_rcp_f32 v132, v132
    v_cvt_pk_bf16_f32 v18, v68, v69
    v_cvt_pk_bf16_f32 v19, v70, v71
    v_cvt_pk_bf16_f32 v20, v72, v73
    v_cvt_pk_bf16_f32 v21, v74, v75
    v_cvt_pk_bf16_f32 v22, v76, v77
    v_cvt_pk_bf16_f32 v23, v78, v79
    v_mul_f32 v132, v132, v130
    v_mov_b32 v125, v130
    v_pk_mul_f32 v[80:81], v[80:81], v[132:133] op_sel_hi:[1,0]
    v_pk_mul_f32 v[82:83], v[82:83], v[132:133] op_sel_hi:[1,0]
    v_pk_mul_f32 v[84:85], v[84:85], v[132:133] op_sel_hi:[1,0]
    v_pk_mul_f32 v[86:87], v[86:87], v[132:133] op_sel_hi:[1,0]
    v_pk_mul_f32 v[88:89], v[88:89], v[132:133] op_sel_hi:[1,0]
    v_pk_mul_f32 v[90:91], v[90:91], v[132:133] op_sel_hi:[1,0]
    v_pk_mul_f32 v[92:93], v[92:93], v[132:133] op_sel_hi:[1,0]
    v_pk_mul_f32 v[94:95], v[94:95], v[132:133] op_sel_hi:[1,0]
    v_cvt_pk_bf16_f32 v24, v80, v81
    v_cvt_pk_bf16_f32 v25, v82, v83
    v_cvt_pk_bf16_f32 v26, v84, v85
    v_cvt_pk_bf16_f32 v27, v86, v87
    v_cvt_pk_bf16_f32 v28, v88, v89
    v_cvt_pk_bf16_f32 v29, v90, v91
    v_cvt_pk_bf16_f32 v30, v92, v93
    v_cvt_pk_bf16_f32 v31, v94, v95
    v_mov_b32 v138, 0xff800000
    v_max3_f32 v128, v32, v33, v34
    v_max3_f32 v129, -v32, -v33, -v34
    v_max3_f32 v134, v40, v41, v42
    v_max3_f32 v135, -v40, -v41, -v42
    v_max3_f32 v128, v128, v35, v36
    v_max3_f32 v129, v129, -v35, -v36
    v_max3_f32 v134, v134, v43, v44
    v_max3_f32 v135, v135, -v43, -v44
    v_max3_f32 v128, v128, v37, v38
    v_max3_f32 v129, v129, -v37, -v38
    v_max3_f32 v134, v134, v45, v46
    v_max3_f32 v135, v135, -v45, -v46
    v_max3_f32 v134, v134, v39, v47
    v_max3_f32 v135, v135, -v39, -v47
    v_max_f32 v128, v128, v134
    v_max_f32 v129, v129, v135
    s_nop 1
    v_permlane32_swap_b32 v128, v129
    v_max_f32 v130, v128, v129
    v_mul_f32 v130, -v104, v130
    v_mov_b32 v132, v130
    s_nop 1
    v_permlane32_swap_b32 v130, v132
    v_cndmask_b32 v131, v130, v138, s[28:29]
    v_cndmask_b32 v133, v132, v138, s[28:29]
    v_pk_fma_f32 v[64:65], v[32:33], v[104:105], v[130:131] op_sel_hi:[1,0,0]
    v_pk_fma_f32 v[80:81], v[32:33], v[104:105], v[132:133] op_sel_hi:[1,0,0] neg_lo:[1,0,0] neg_hi:[1,0,0]
    v_pk_fma_f32 v[66:67], v[34:35], v[104:105], v[130:131] op_sel_hi:[1,0,0]
    v_pk_fma_f32 v[82:83], v[34:35], v[104:105], v[132:133] op_sel_hi:[1,0,0] neg_lo:[1,0,0] neg_hi:[1,0,0]
    v_pk_fma_f32 v[68:69], v[36:37], v[104:105], v[130:131] op_sel_hi:[1,0,0]
    v_pk_fma_f32 v[84:85], v[36:37], v[104:105], v[132:133] op_sel_hi:[1,0,0] neg_lo:[1,0,0] neg_hi:[1,0,0]
    v_pk_fma_f32 v[70:71], v[38:39], v[104:105], v[130:131] op_sel_hi:[1,0,0]
    v_pk_fma_f32 v[86:87], v[38:39], v[104:105], v[132:133] op_sel_hi:[1,0,0] neg_lo:[1,0,0] neg_hi:[1,0,0]
    v_pk_fma_f32 v[72:73], v[40:41], v[104:105], v[130:131] op_sel_hi:[1,0,0]
    v_pk_fma_f32 v[88:89], v[40:41], v[104:105], v[132:133] op_sel_hi:[1,0,0] neg_lo:[1,0,0] neg_hi:[1,0,0]
    v_pk_fma_f32 v[74:75], v[42:43], v[104:105], v[130:131] op_sel_hi:[1,0,0]
    v_pk_fma_f32 v[90:91], v[42:43], v[104:105], v[132:133] op_sel_hi:[1,0,0] neg_lo:[1,0,0] neg_hi:[1,0,0]
    v_pk_fma_f32 v[76:77], v[44:45], v[104:105], v[130:131] op_sel:[0,0,1] op_sel_hi:[1,0,1]
    v_pk_fma_f32 v[92:93], v[44:45], v[104:105], v[132:133] op_sel:[0,0,1] op_sel_hi:[1,0,1] neg_lo:[1,0,0] neg_hi:[1,0,0]
    v_pk_fma_f32 v[78:79], v[46:47], v[104:105], v[130:131] op_sel:[0,0,1] op_sel_hi:[1,0,1]
    v_pk_fma_f32 v[94:95], v[46:47], v[104:105], v[132:133] op_sel:[0,0,1] op_sel_hi:[1,0,1] neg_lo:[1,0,0] neg_hi:[1,0,0]
    v_exp_f32 v64, v64
    v_exp_f32 v80, v80
    v_exp_f32 v65, v65
    v_exp_f32 v81, v81
    v_exp_f32 v66, v66
    v_exp_f32 v82, v82
    v_exp_f32 v67, v67
    v_exp_f32 v83, v83
    v_exp_f32 v68, v68
    v_exp_f32 v84, v84
    v_exp_f32 v69, v69
    v_exp_f32 v85, v85
    v_exp_f32 v70, v70
    v_exp_f32 v86, v86
    v_exp_f32 v71, v71
    v_exp_f32 v87, v87
    v_exp_f32 v72, v72
    v_exp_f32 v88, v88
    v_exp_f32 v73, v73
    v_exp_f32 v89, v89
    v_exp_f32 v74, v74
    v_exp_f32 v90, v90
    v_exp_f32 v75, v75
    v_exp_f32 v91, v91
    v_exp_f32 v76, v76
    v_exp_f32 v92, v92
    v_exp_f32 v77, v77
    v_exp_f32 v93, v93
    v_exp_f32 v78, v78
    v_exp_f32 v94, v94
    v_exp_f32 v79, v79
    v_exp_f32 v95, v95
    v_pk_add_f32 v[134:135], v[64:65], v[66:67]
    v_pk_add_f32 v[136:137], v[80:81], v[82:83]
    v_pk_add_f32 v[134:135], v[134:135], v[68:69]
    v_pk_add_f32 v[136:137], v[136:137], v[84:85]
    v_pk_add_f32 v[134:135], v[134:135], v[70:71]
    v_pk_add_f32 v[136:137], v[136:137], v[86:87]
    v_pk_add_f32 v[134:135], v[134:135], v[72:73]
    v_pk_add_f32 v[136:137], v[136:137], v[88:89]
    v_pk_add_f32 v[134:135], v[134:135], v[74:75]
    v_pk_add_f32 v[136:137], v[136:137], v[90:91]
    v_pk_add_f32 v[134:135], v[134:135], v[76:77]
    v_pk_add_f32 v[136:137], v[136:137], v[92:93]
    v_pk_add_f32 v[134:135], v[134:135], v[78:79]
    v_pk_add_f32 v[136:137], v[136:137], v[94:95]
    v_add_f32 v134, v134, v135
    v_add_f32 v136, v136, v137
    s_nop 1
    v_permlane32_swap_b32 v134, v136
    v_add_f32 v130, v134, v136
    v_mov_b32 v132, v130
    v_cvt_pk_bf16_f32 v32, v64, v65
    v_cvt_pk_bf16_f32 v33, v66, v67
    v_permlane32_swap_b32 v130, v132
    v_rcp_f32 v132, v132
    v_cvt_pk_bf16_f32 v34, v68, v69
    v_cvt_pk_bf16_f32 v35, v70, v71
    v_cvt_pk_bf16_f32 v36, v72, v73
    v_cvt_pk_bf16_f32 v37, v74, v75
    v_cvt_pk_bf16_f32 v38, v76, v77
    v_cvt_pk_bf16_f32 v39, v78, v79
    v_mul_f32 v132, v132, v130
    v_mov_b32 v126, v130
    v_pk_mul_f32 v[80:81], v[80:81], v[132:133] op_sel_hi:[1,0]
    v_pk_mul_f32 v[82:83], v[82:83], v[132:133] op_sel_hi:[1,0]
    v_pk_mul_f32 v[84:85], v[84:85], v[132:133] op_sel_hi:[1,0]
    v_pk_mul_f32 v[86:87], v[86:87], v[132:133] op_sel_hi:[1,0]
    v_pk_mul_f32 v[88:89], v[88:89], v[132:133] op_sel_hi:[1,0]
    v_pk_mul_f32 v[90:91], v[90:91], v[132:133] op_sel_hi:[1,0]
    v_pk_mul_f32 v[92:93], v[92:93], v[132:133] op_sel_hi:[1,0]
    v_pk_mul_f32 v[94:95], v[94:95], v[132:133] op_sel_hi:[1,0]
    v_cvt_pk_bf16_f32 v40, v80, v81
    v_cvt_pk_bf16_f32 v41, v82, v83
    v_cvt_pk_bf16_f32 v42, v84, v85
    v_cvt_pk_bf16_f32 v43, v86, v87
    v_cvt_pk_bf16_f32 v44, v88, v89
    v_cvt_pk_bf16_f32 v45, v90, v91
    v_cvt_pk_bf16_f32 v46, v92, v93
    v_cvt_pk_bf16_f32 v47, v94, v95
    v_mov_b32 v138, 0xff800000
    v_max3_f32 v128, v48, v49, v50
    v_max3_f32 v129, -v48, -v49, -v50
    v_max3_f32 v134, v56, v57, v58
    v_max3_f32 v135, -v56, -v57, -v58
    v_max3_f32 v128, v128, v51, v52
    v_max3_f32 v129, v129, -v51, -v52
    v_max3_f32 v134, v134, v59, v60
    v_max3_f32 v135, v135, -v59, -v60
    v_max3_f32 v128, v128, v53, v54
    v_max3_f32 v129, v129, -v53, -v54
    v_max3_f32 v134, v134, v61, v62
    v_max3_f32 v135, v135, -v61, -v62
    v_max3_f32 v134, v134, v55, v63
    v_max3_f32 v135, v135, -v55, -v63
    v_max_f32 v128, v128, v134
    v_max_f32 v129, v129, v135
    s_nop 1
    v_permlane32_swap_b32 v128, v129
    v_max_f32 v130, v128, v129
    v_mul_f32 v130, -v104, v130
    v_mov_b32 v132, v130
    s_nop 1
    v_permlane32_swap_b32 v130, v132
    v_cndmask_b32 v131, v130, v138, s[28:29]
    v_cndmask_b32 v133, v132, v138, s[28:29]
    v_pk_fma_f32 v[64:65], v[48:49], v[104:105], v[130:131] op_sel_hi:[1,0,0]
    v_pk_fma_f32 v[80:81], v[48:49], v[104:105], v[132:133] op_sel_hi:[1,0,0] neg_lo:[1,0,0] neg_hi:[1,0,0]
    v_pk_fma_f32 v[66:67], v[50:51], v[104:105], v[130:131] op_sel_hi:[1,0,0]
    v_pk_fma_f32 v[82:83], v[50:51], v[104:105], v[132:133] op_sel_hi:[1,0,0] neg_lo:[1,0,0] neg_hi:[1,0,0]
    v_pk_fma_f32 v[68:69], v[52:53], v[104:105], v[130:131] op_sel_hi:[1,0,0]
    v_pk_fma_f32 v[84:85], v[52:53], v[104:105], v[132:133] op_sel_hi:[1,0,0] neg_lo:[1,0,0] neg_hi:[1,0,0]
    v_pk_fma_f32 v[70:71], v[54:55], v[104:105], v[130:131] op_sel_hi:[1,0,0]
    v_pk_fma_f32 v[86:87], v[54:55], v[104:105], v[132:133] op_sel_hi:[1,0,0] neg_lo:[1,0,0] neg_hi:[1,0,0]
    v_pk_fma_f32 v[72:73], v[56:57], v[104:105], v[130:131] op_sel_hi:[1,0,0]
    v_pk_fma_f32 v[88:89], v[56:57], v[104:105], v[132:133] op_sel_hi:[1,0,0] neg_lo:[1,0,0] neg_hi:[1,0,0]
    v_pk_fma_f32 v[74:75], v[58:59], v[104:105], v[130:131] op_sel_hi:[1,0,0]
    v_pk_fma_f32 v[90:91], v[58:59], v[104:105], v[132:133] op_sel_hi:[1,0,0] neg_lo:[1,0,0] neg_hi:[1,0,0]
    v_pk_fma_f32 v[76:77], v[60:61], v[104:105], v[130:131] op_sel:[0,0,1] op_sel_hi:[1,0,1]
    v_pk_fma_f32 v[92:93], v[60:61], v[104:105], v[132:133] op_sel:[0,0,1] op_sel_hi:[1,0,1] neg_lo:[1,0,0] neg_hi:[1,0,0]
    v_pk_fma_f32 v[78:79], v[62:63], v[104:105], v[130:131] op_sel:[0,0,1] op_sel_hi:[1,0,1]
    v_pk_fma_f32 v[94:95], v[62:63], v[104:105], v[132:133] op_sel:[0,0,1] op_sel_hi:[1,0,1] neg_lo:[1,0,0] neg_hi:[1,0,0]
    v_exp_f32 v64, v64
    v_exp_f32 v80, v80
    v_exp_f32 v65, v65
    v_exp_f32 v81, v81
    v_exp_f32 v66, v66
    v_exp_f32 v82, v82
    v_exp_f32 v67, v67
    v_exp_f32 v83, v83
    v_exp_f32 v68, v68
    v_exp_f32 v84, v84
    v_exp_f32 v69, v69
    v_exp_f32 v85, v85
    v_exp_f32 v70, v70
    v_exp_f32 v86, v86
    v_exp_f32 v71, v71
    v_exp_f32 v87, v87
    v_exp_f32 v72, v72
    v_exp_f32 v88, v88
    v_exp_f32 v73, v73
    v_exp_f32 v89, v89
    v_exp_f32 v74, v74
    v_exp_f32 v90, v90
    v_exp_f32 v75, v75
    v_exp_f32 v91, v91
    v_exp_f32 v76, v76
    v_exp_f32 v92, v92
    v_exp_f32 v77, v77
    v_exp_f32 v93, v93
    v_exp_f32 v78, v78
    v_exp_f32 v94, v94
    v_exp_f32 v79, v79
    v_exp_f32 v95, v95
    v_pk_add_f32 v[134:135], v[64:65], v[66:67]
    v_pk_add_f32 v[136:137], v[80:81], v[82:83]
    v_pk_add_f32 v[134:135], v[134:135], v[68:69]
    v_pk_add_f32 v[136:137], v[136:137], v[84:85]
    v_pk_add_f32 v[134:135], v[134:135], v[70:71]
    v_pk_add_f32 v[136:137], v[136:137], v[86:87]
    v_pk_add_f32 v[134:135], v[134:135], v[72:73]
    v_pk_add_f32 v[136:137], v[136:137], v[88:89]
    v_pk_add_f32 v[134:135], v[134:135], v[74:75]
    v_pk_add_f32 v[136:137], v[136:137], v[90:91]
    v_pk_add_f32 v[134:135], v[134:135], v[76:77]
    v_pk_add_f32 v[136:137], v[136:137], v[92:93]
    v_pk_add_f32 v[134:135], v[134:135], v[78:79]
    v_pk_add_f32 v[136:137], v[136:137], v[94:95]
    v_add_f32 v134, v134, v135
    v_add_f32 v136, v136, v137
    s_nop 1
    v_permlane32_swap_b32 v134, v136
    v_add_f32 v130, v134, v136
    v_mov_b32 v132, v130
    v_cvt_pk_bf16_f32 v48, v64, v65
    v_cvt_pk_bf16_f32 v49, v66, v67
    v_permlane32_swap_b32 v130, v132
    v_rcp_f32 v132, v132
    v_cvt_pk_bf16_f32 v50, v68, v69
    v_cvt_pk_bf16_f32 v51, v70, v71
    v_cvt_pk_bf16_f32 v52, v72, v73
    v_cvt_pk_bf16_f32 v53, v74, v75
    v_cvt_pk_bf16_f32 v54, v76, v77
    v_cvt_pk_bf16_f32 v55, v78, v79
    v_mul_f32 v132, v132, v130
    v_mov_b32 v127, v130
    v_pk_mul_f32 v[80:81], v[80:81], v[132:133] op_sel_hi:[1,0]
    v_pk_mul_f32 v[82:83], v[82:83], v[132:133] op_sel_hi:[1,0]
    v_pk_mul_f32 v[84:85], v[84:85], v[132:133] op_sel_hi:[1,0]
    v_pk_mul_f32 v[86:87], v[86:87], v[132:133] op_sel_hi:[1,0]
    v_pk_mul_f32 v[88:89], v[88:89], v[132:133] op_sel_hi:[1,0]
    v_pk_mul_f32 v[90:91], v[90:91], v[132:133] op_sel_hi:[1,0]
    v_pk_mul_f32 v[92:93], v[92:93], v[132:133] op_sel_hi:[1,0]
    v_pk_mul_f32 v[94:95], v[94:95], v[132:133] op_sel_hi:[1,0]
    v_cvt_pk_bf16_f32 v56, v80, v81
    v_cvt_pk_bf16_f32 v57, v82, v83
    v_cvt_pk_bf16_f32 v58, v84, v85
    v_cvt_pk_bf16_f32 v59, v86, v87
    v_cvt_pk_bf16_f32 v60, v88, v89
    v_cvt_pk_bf16_f32 v61, v90, v91
    v_cvt_pk_bf16_f32 v62, v92, v93
    v_cvt_pk_bf16_f32 v63, v94, v95
    v_lshrrev_b32 v128, 4, v140
    s_lshl_b32 s8, s5, 1
    v_add_u32 v128, s8, v128
    s_mul_i32 s8, s5, 3
    s_add_u32 s8, s8, 2
    v_min_u32 v128, s8, v128
    v_and_b32 v129, 15, v140
    v_lshl_add_u32 v128, v128, 4, v129
    v_lshlrev_b32 v128, 7, v128
    s_mov_b32 s11, 11894784
    v_lshrrev_b32 v130, 3, v140
    v_and_b32 v131, 7, v140
    v_lshlrev_b32 v132, 4, v131
    v_lshl_add_u32 v132, v130, 8, v132
    s_add_u32 s8, s24, s4
    s_lshl_b32 s8, s8, 13
    s_add_u32 s0, s8, 10485760
    s_add_u32 s1, s0, 4096
    v_lshrrev_b32 v133, 1, v131
    v_lshlrev_b32 v133, 10, v133
    v_and_b32 v131, 1, v131
    v_lshl_add_u32 v133, v131, 3, v133
    s_lshl_b32 s8, s4, 12
    v_add_u32 v133, s8, v133
    v_add_u32 v134, 0, v130
    v_cmp_lt_u32 vcc, 13, v134
    v_subrev_u32 v135, 14, v134
    s_nop 0
    v_cndmask_b32 v135, v134, v135, vcc
    v_cndmask_b32 v131, 0, 4, vcc
    v_and_or_b32 v131, v135, 3, v131
    v_lshrrev_b32 v135, 2, v135
    v_lshl_add_u32 v131, v135, 3, v131
    v_lshl_add_u32 v112, v131, 4, v133
    v_add_u32 v134, 8, v130
    v_cmp_lt_u32 vcc, 13, v134
    v_subrev_u32 v135, 14, v134
    s_nop 0
    v_cndmask_b32 v135, v134, v135, vcc
    v_cndmask_b32 v131, 0, 4, vcc
    v_and_or_b32 v131, v135, 3, v131
    v_lshrrev_b32 v135, 2, v135
    v_lshl_add_u32 v131, v135, 3, v131
    v_lshl_add_u32 v113, v131, 4, v133
    v_add_u32 v134, 16, v130
    v_cmp_lt_u32 vcc, 13, v134
    v_subrev_u32 v135, 14, v134
    s_nop 0
    v_cndmask_b32 v135, v134, v135, vcc
    v_cndmask_b32 v131, 0, 4, vcc
    v_and_or_b32 v131, v135, 3, v131
    v_lshrrev_b32 v135, 2, v135
    v_lshl_add_u32 v131, v135, 3, v131
    v_lshl_add_u32 v114, v131, 4, v133
    v_add_u32 v134, 24, v130
    v_cmp_lt_u32 vcc, 13, v134
    v_subrev_u32 v135, 14, v134
    s_nop 0
    v_cndmask_b32 v135, v134, v135, vcc
    v_cndmask_b32 v131, 0, 4, vcc
    v_cmp_lt_u32 vcc, 27, v134
    v_and_b32 v136, 1, v134
    v_lshlrev_b32 v136, 2, v136
    v_cndmask_b32 v131, v131, v136, vcc
    v_bfe_u32 v136, v134, 1, 1
    v_add_u32 v136, 14, v136
    v_cndmask_b32 v135, v135, v136, vcc
    v_and_or_b32 v131, v135, 3, v131
    v_lshrrev_b32 v135, 2, v135
    v_lshl_add_u32 v131, v135, 3, v131
    v_lshl_add_u32 v115, v131, 4, v133
    s_lshl_b32 s8, s69, 14
    v_add_u32 v130, s8, v141
    s_lshl_b32 s8, s6, 2
    s_add_u32 s10, s8, s68
    s_mul_i32 s8, s10, 28
    s_mul_i32 s9, s5, 14
    s_add_u32 s8, s8, s9
    s_mul_i32 s9, s69, 7
    s_add_u32 s8, s8, s9
    s_lshl_b32 s8, s8, 10
    s_add_u32 s20, s8, 8388608
    s_add_u32 s21, s20, 4096
    s_lshl_b32 s8, s10, 1
    s_add_u32 s8, s8, s5
    s_lshl_b32 s8, s8, 1
    s_add_u32 s8, s8, s69
    s_lshl_b32 s8, s8, 7
    s_add_u32 s22, s8, 11829248
    s_cmp_lg_u32 s4, 0
    s_cbranch_scc1 L_polldkv
L_pollkv:
    buffer_load_dword v64, v128, s[64:67], s11 offen sc1
    s_waitcnt vmcnt(0)
    v_cmp_ne_u32 vcc, s35, v64
    s_nop 1
    s_cbranch_vccz L_polldkv
    s_nop 0
    s_add_u32 s31, s31, 1
    s_cmp_lt_u32 s31, 0x8000
    s_cbranch_scc1 L_pollkv
L_polldkv:
    s_barrier
    buffer_load_dwordx4 v[64:67], v132, s[64:67], s0 offen offset:0 sc1
    buffer_load_dwordx4 v[68:71], v132, s[64:67], s0 offen offset:2048 sc1
    buffer_load_dwordx4 v[72:75], v132, s[64:67], s1 offen offset:0 sc1
    buffer_load_dwordx4 v[76:79], v132, s[64:67], s1 offen offset:2048 sc1
    buffer_load_dwordx4 v[80:83], v132, s[64:67], s0 offen offset:128 sc1
    buffer_load_dwordx4 v[84:87], v132, s[64:67], s0 offen offset:2176 sc1
    buffer_load_dwordx4 v[88:91], v132, s[64:67], s1 offen offset:128 sc1
    buffer_load_dwordx4 v[92:95], v132, s[64:67], s1 offen offset:2176 sc1
    s_waitcnt vmcnt(7)
    v_cvt_pk_bf16_f32 v64, v64, v65
    v_cvt_pk_bf16_f32 v65, v66, v67
    ds_write_b64 v112, v[64:65] offset:0
    s_waitcnt vmcnt(6)
    v_cvt_pk_bf16_f32 v68, v68, v69
    v_cvt_pk_bf16_f32 v69, v70, v71
    ds_write_b64 v113, v[68:69] offset:0
    s_waitcnt vmcnt(5)
    v_cvt_pk_bf16_f32 v72, v72, v73
    v_cvt_pk_bf16_f32 v73, v74, v75
    ds_write_b64 v114, v[72:73] offset:0
    s_waitcnt vmcnt(4)
    v_cvt_pk_bf16_f32 v76, v76, v77
    v_cvt_pk_bf16_f32 v77, v78, v79
    ds_write_b64 v115, v[76:77] offset:0
    s_waitcnt vmcnt(3)
    v_cvt_pk_bf16_f32 v80, v80, v81
    v_cvt_pk_bf16_f32 v81, v82, v83
    ds_write_b64 v112, v[80:81] offset:512
    s_waitcnt vmcnt(2)
    v_cvt_pk_bf16_f32 v84, v84, v85
    v_cvt_pk_bf16_f32 v85, v86, v87
    ds_write_b64 v113, v[84:85] offset:512
    s_waitcnt vmcnt(1)
    v_cvt_pk_bf16_f32 v88, v88, v89
    v_cvt_pk_bf16_f32 v89, v90, v91
    ds_write_b64 v114, v[88:89] offset:512
    s_waitcnt vmcnt(0)
    v_cvt_pk_bf16_f32 v92, v92, v93
    v_cvt_pk_bf16_f32 v93, v94, v95
    ds_write_b64 v115, v[92:93] offset:512
    s_waitcnt lgkmcnt(0)
    s_barrier
    ds_read_b128 a[32:35], v130 offset:0
    ds_read_b128 a[36:39], v130 offset:1024
    ds_read_b128 a[40:43], v130 offset:2048
    ds_read_b128 a[44:47], v130 offset:3072
    ds_read_b128 a[48:51], v130 offset:4096
    ds_read_b128 a[52:55], v130 offset:5120
    ds_read_b128 a[56:59], v130 offset:6144
    ds_read_b128 a[60:63], v130 offset:7168
    ds_read_b128 a[64:67], v130 offset:8192
    ds_read_b128 a[68:71], v130 offset:9216
    ds_read_b128 a[72:75], v130 offset:10240
    ds_read_b128 a[76:79], v130 offset:11264
    ds_read_b128 a[80:83], v130 offset:12288
    ds_read_b128 a[84:87], v130 offset:13312
    ds_read_b128 a[88:91], v130 offset:14336
    ds_read_b128 a[92:95], v130 offset:15360
    s_waitcnt lgkmcnt(15)
    v_mfma_f32_32x32x16_bf16 v[64:79], a[32:35], v[0:3], 0
    s_waitcnt lgkmcnt(14)
    v_mfma_f32_32x32x16_bf16 v[64:79], a[36:39], v[4:7], v[64:79]
    s_waitcnt lgkmcnt(13)
    v_mfma_f32_32x32x16_bf16 v[64:79], a[40:43], v[8:11], v[64:79]
    s_waitcnt lgkmcnt(12)
    v_mfma_f32_32x32x16_bf16 v[64:79], a[44:47], v[12:15], v[64:79]
    s_waitcnt lgkmcnt(11)
    v_mfma_f32_32x32x16_bf16 v[80:95], a[48:51], v[16:19], 0
    s_waitcnt lgkmcnt(10)
    v_mfma_f32_32x32x16_bf16 v[80:95], a[52:55], v[20:23], v[80:95]
    s_waitcnt lgkmcnt(9)
    v_mfma_f32_32x32x16_bf16 v[80:95], a[56:59], v[24:27], v[80:95]
    s_waitcnt lgkmcnt(8)
    v_mfma_f32_32x32x16_bf16 v[80:95], a[60:63], v[28:31], v[80:95]
    s_waitcnt lgkmcnt(7)
    v_mfma_f32_32x32x16_bf16 v[0:15], a[64:67], v[32:35], 0
    s_nop 1
    v_fmac_f32 v78, 0x358637bd, v124
    v_rcp_f32 v136, v78
    s_nop 0
    v_mul_f32 v64, v64, v136
    v_mul_f32 v65, v65, v136
    v_mul_f32 v66, v66, v136
    s_waitcnt lgkmcnt(6)
    v_mfma_f32_32x32x16_bf16 v[0:15], a[68:71], v[36:39], v[0:15]
    v_mul_f32 v67, v67, v136
    v_mul_f32 v68, v68, v136
    v_mul_f32 v69, v69, v136
    v_mul_f32 v70, v70, v136
    v_mul_f32 v71, v71, v136
    s_waitcnt lgkmcnt(5)
    v_mfma_f32_32x32x16_bf16 v[0:15], a[72:75], v[40:43], v[0:15]
    v_mul_f32 v72, v72, v136
    v_mul_f32 v73, v73, v136
    v_mul_f32 v74, v74, v136
    v_mul_f32 v75, v75, v136
    v_mul_f32 v76, v76, v136
    s_waitcnt lgkmcnt(4)
    v_mfma_f32_32x32x16_bf16 v[0:15], a[76:79], v[44:47], v[0:15]
    v_mul_f32 v77, v77, v136
    v_cvt_pk_bf16_f32 v96, v64, v65
    v_cvt_pk_bf16_f32 v97, v66, v67
    v_cvt_pk_bf16_f32 v98, v68, v69
    v_cvt_pk_bf16_f32 v99, v70, v71
    v_cvt_pk_bf16_f32 v100, v72, v73
    v_cvt_pk_bf16_f32 v101, v74, v75
    v_cvt_pk_bf16_f32 v102, v76, v77
    buffer_store_dwordx4 v[96:99], v141, s[64:67], s20 offen offset:0 sc1
    s_waitcnt lgkmcnt(3)
    v_mfma_f32_32x32x16_bf16 v[16:31], a[80:83], v[48:51], 0
    v_fmac_f32 v94, 0x358637bd, v125
    v_rcp_f32 v136, v94
    s_nop 0
    v_mul_f32 v80, v80, v136
    v_mul_f32 v81, v81, v136
    v_mul_f32 v82, v82, v136
    s_waitcnt lgkmcnt(2)
    v_mfma_f32_32x32x16_bf16 v[16:31], a[84:87], v[52:55], v[16:31]
    v_mul_f32 v83, v83, v136
    v_mul_f32 v84, v84, v136
    v_mul_f32 v85, v85, v136
    v_mul_f32 v86, v86, v136
    v_mul_f32 v87, v87, v136
    s_waitcnt lgkmcnt(1)
    v_mfma_f32_32x32x16_bf16 v[16:31], a[88:91], v[56:59], v[16:31]
    v_mul_f32 v88, v88, v136
    v_mul_f32 v89, v89, v136
    v_mul_f32 v90, v90, v136
    v_mul_f32 v91, v91, v136
    v_mul_f32 v92, v92, v136
    s_waitcnt lgkmcnt(0)
    v_mfma_f32_32x32x16_bf16 v[16:31], a[92:95], v[60:63], v[16:31]
    v_mul_f32 v93, v93, v136
    v_cvt_pk_bf16_f32 v103, v80, v81
    v_cvt_pk_bf16_f32 v104, v82, v83
    v_cvt_pk_bf16_f32 v105, v84, v85
    v_cvt_pk_bf16_f32 v106, v86, v87
    v_cvt_pk_bf16_f32 v107, v88, v89
    v_cvt_pk_bf16_f32 v108, v90, v91
    v_cvt_pk_bf16_f32 v109, v92, v93
    buffer_store_dwordx4 v[100:103], v141, s[64:67], s20 offen offset:1024 sc1
    buffer_store_dwordx4 v[104:107], v141, s[64:67], s20 offen offset:2048 sc1
    v_fmac_f32 v14, 0x358637bd, v126
    v_rcp_f32 v136, v14
    s_nop 0
    v_mul_f32 v0, v0, v136
    v_mul_f32 v1, v1, v136
    v_mul_f32 v2, v2, v136
    v_mul_f32 v3, v3, v136
    v_mul_f32 v4, v4, v136
    v_mul_f32 v5, v5, v136
    v_mul_f32 v6, v6, v136
    v_mul_f32 v7, v7, v136
    v_mul_f32 v8, v8, v136
    v_mul_f32 v9, v9, v136
    v_mul_f32 v10, v10, v136
    v_mul_f32 v11, v11, v136
    v_mul_f32 v12, v12, v136
    v_mul_f32 v13, v13, v136
    v_cvt_pk_bf16_f32 v110, v0, v1
    v_cvt_pk_bf16_f32 v111, v2, v3
    v_cvt_pk_bf16_f32 v112, v4, v5
    v_cvt_pk_bf16_f32 v113, v6, v7
    v_cvt_pk_bf16_f32 v114, v8, v9
    v_cvt_pk_bf16_f32 v115, v10, v11
    v_cvt_pk_bf16_f32 v116, v12, v13
    buffer_store_dwordx4 v[108:111], v141, s[64:67], s20 offen offset:3072 sc1
    buffer_store_dwordx4 v[112:115], v141, s[64:67], s21 offen offset:0 sc1
    v_fmac_f32 v30, 0x358637bd, v127
    v_rcp_f32 v136, v30
    s_nop 0
    v_mul_f32 v16, v16, v136
    v_mul_f32 v17, v17, v136
    v_mul_f32 v18, v18, v136
    v_mul_f32 v19, v19, v136
    v_mul_f32 v20, v20, v136
    v_mul_f32 v21, v21, v136
    v_mul_f32 v22, v22, v136
    v_mul_f32 v23, v23, v136
    v_mul_f32 v24, v24, v136
    v_mul_f32 v25, v25, v136
    v_mul_f32 v26, v26, v136
    v_mul_f32 v27, v27, v136
    v_mul_f32 v28, v28, v136
    v_mul_f32 v29, v29, v136
    v_cvt_pk_bf16_f32 v117, v16, v17
    v_cvt_pk_bf16_f32 v118, v18, v19
    v_cvt_pk_bf16_f32 v119, v20, v21
    v_cvt_pk_bf16_f32 v120, v22, v23
    v_cvt_pk_bf16_f32 v121, v24, v25
    v_cvt_pk_bf16_f32 v122, v26, v27
    v_cvt_pk_bf16_f32 v123, v28, v29
    buffer_store_dwordx4 v[116:119], v141, s[64:67], s21 offen offset:1024 sc1
    buffer_store_dwordx4 v[120:123], v141, s[64:67], s21 offen offset:2048 sc1
    s_waitcnt vmcnt(0)
    v_mov_b32 v128, s35
    v_mov_b32 v129, 0
    s_mov_b64 exec, 1
    buffer_store_dword v128, v129, s[64:67], s22 offen sc1
    s_mov_b64 exec, -1
    s_waitcnt vmcnt(0)
    s_endpgm
    s_nop 0
L_p2:
    v_cmp_ne_u32 vcc, s35, v128
    s_nop 1
    s_cbranch_vccz L_polldA
L_pollA:
    buffer_load_dword v128, v129, s[64:67], s98 offen sc1
    s_waitcnt vmcnt(0)
    v_cmp_ne_u32 vcc, s35, v128
    s_nop 1
    s_cbranch_vccz L_polldA
    s_nop 0
    s_add_u32 s31, s31, 1
    s_cmp_lt_u32 s31, 0x8000
    s_cbranch_scc1 L_pollA
L_polldA:
    buffer_load_dwordx4 v[64:67], v141, s[64:67], s20 offen offset:0 sc1
    buffer_load_dwordx4 v[68:71], v141, s[64:67], s21 offen offset:0 sc1
    buffer_load_dwordx4 v[72:75], v141, s[64:67], s20 offen offset:1024 sc1
    buffer_load_dwordx4 v[76:79], v141, s[64:67], s21 offen offset:1024 sc1
    buffer_load_dwordx4 v[80:83], v141, s[64:67], s20 offen offset:2048 sc1
    buffer_load_dwordx4 v[84:87], v141, s[64:67], s21 offen offset:2048 sc1
    buffer_load_dwordx4 v[88:91], v141, s[64:67], s20 offen offset:3072 sc1
    s_add_u32 s20, s20, 4096
    buffer_load_dwordx4 v[92:95], v141, s[64:67], s21 offen offset:3072 sc1
    s_add_u32 s21, s21, 4096
    buffer_load_dwordx4 v[96:99], v141, s[64:67], s20 offen offset:0 sc1
    buffer_load_dwordx4 v[100:103], v141, s[64:67], s21 offen offset:0 sc1
    buffer_load_dwordx4 v[104:107], v141, s[64:67], s20 offen offset:1024 sc1
    buffer_load_dwordx4 v[108:111], v141, s[64:67], s21 offen offset:1024 sc1
    buffer_load_dwordx4 v[112:115], v141, s[64:67], s20 offen offset:2048 sc1
    buffer_load_dwordx4 v[116:119], v141, s[64:67], s21 offen offset:2048 sc1
    buffer_load_dwordx4 v[120:123], v141, s[64:67], s20 offen offset:3072 sc1
    s_add_u32 s20, s20, 4096
    s_waitcnt vmcnt(14)
    v_mfma_f32_32x32x16_bf16 v[0:15], a[0:3], v[64:67], 0
    v_mfma_f32_32x32x16_bf16 v[16:31], a[4:7], v[64:67], 0
    buffer_load_dwordx4 v[64:67], v141, s[64:67], s21 offen offset:3072 sc1
    s_add_u32 s21, s21, 4096
    s_waitcnt vmcnt(14)
    v_mfma_f32_32x32x16_bf16 v[32:47], a[0:3], v[68:71], 0
    v_mfma_f32_32x32x16_bf16 v[48:63], a[4:7], v[68:71], 0
    buffer_load_dwordx4 v[68:71], v141, s[64:67], s20 offen offset:0 sc1
    ds_read_b64_tr_b16 a[72:73], v126 offset:0
    ds_read_b64_tr_b16 a[74:75], v126 offset:1024
    ds_read_b64_tr_b16 a[76:77], v127 offset:0
    ds_read_b64_tr_b16 a[78:79], v127 offset:1024
    ds_read_b64_tr_b16 a[80:81], v142 offset:0
    ds_read_b64_tr_b16 a[82:83], v142 offset:1024
    ds_read_b64_tr_b16 a[84:85], v143 offset:0
    ds_read_b64_tr_b16 a[86:87], v143 offset:1024
    ds_read_b64_tr_b16 a[88:89], v142 offset:2048
    ds_read_b64_tr_b16 a[90:91], v142 offset:3072
    ds_read_b64_tr_b16 a[92:93], v143 offset:2048
    ds_read_b64_tr_b16 a[94:95], v143 offset:3072
    ds_read_b64_tr_b16 a[96:97], v142 offset:32768
    ds_read_b64_tr_b16 a[98:99], v142 offset:33792
    ds_read_b64_tr_b16 a[100:101], v143 offset:32768
    ds_read_b64_tr_b16 a[102:103], v143 offset:33792
    ds_read_b64_tr_b16 a[104:105], v142 offset:34816
    ds_read_b64_tr_b16 a[106:107], v142 offset:35840
    ds_read_b64_tr_b16 a[108:109], v143 offset:34816
    ds_read_b64_tr_b16 a[110:111], v143 offset:35840
    s_waitcnt vmcnt(14)
    v_mfma_f32_32x32x16_bf16 v[0:15], a[8:11], v[72:75], v[0:15]
    v_mfma_f32_32x32x16_bf16 v[16:31], a[12:15], v[72:75], v[16:31]
    buffer_load_dwordx4 v[72:75], v141, s[64:67], s21 offen offset:0 sc1
    s_waitcnt vmcnt(14)
    v_mfma_f32_32x32x16_bf16 v[32:47], a[8:11], v[76:79], v[32:47]
    v_mfma_f32_32x32x16_bf16 v[48:63], a[12:15], v[76:79], v[48:63]
    buffer_load_dwordx4 v[76:79], v141, s[64:67], s20 offen offset:1024 sc1
    s_waitcnt vmcnt(14)
    v_mfma_f32_32x32x16_bf16 v[0:15], a[16:19], v[80:83], v[0:15]
    v_mfma_f32_32x32x16_bf16 v[16:31], a[20:23], v[80:83], v[16:31]
    buffer_load_dwordx4 v[80:83], v141, s[64:67], s21 offen offset:1024 sc1
    s_waitcnt vmcnt(14)
    v_mfma_f32_32x32x16_bf16 v[32:47], a[16:19], v[84:87], v[32:47]
    v_mfma_f32_32x32x16_bf16 v[48:63], a[20:23], v[84:87], v[48:63]
    buffer_load_dwordx4 v[84:87], v141, s[64:67], s20 offen offset:2048 sc1
    v_and_b32 v132, 31, v140
    v_lshlrev_b32 v132, 7, v132
    v_and_b32 v133, 7, v140
    v_lshl_add_u32 v132, v133, 4, v132
    v_lshrrev_b32 v133, 5, v140
    v_lshl_add_u32 v132, v133, 3, v132
    v_add_u32 v124, s19, v132
    s_lshl_b32 s8, s69, 13
    s_bfe_u32 s9, s4, 0x10001
    s_lshl_b32 s10, s9, 12
    s_add_u32 s8, s8, s10
    s_add_u32 s8, s8, 131072
    v_add_u32 v142, s8, v132
    s_and_b32 s8, s4, 1
    s_lshl_b32 s8, s8, 6
    v_xor_b32 v142, s8, v142
    v_lshrrev_b32 v132, 3, v140
    v_and_b32 v133, 7, v140
    v_xor_b32 v133, v133, v132
    v_lshlrev_b32 v132, 7, v132
    v_lshl_add_u32 v132, v133, 4, v132
    s_lshl_b32 s8, s4, 10
    s_add_u32 s8, s8, 131072
    v_add_u32 v143, s8, v132
    s_lshl_b32 s8, s68, 10
    s_lshl_b32 s9, s69, 15
    s_add_u32 s8, s8, s9
    s_add_u32 s8, s8, 57344
    v_add_u32 v127, s8, v132
    s_add_u32 s25, s22, 4096
    s_add_u32 s28, s22, 8192
    s_add_u32 s29, s22, 12288
    s_mov_b32 s10, 0x00003f80
    s_mov_b32 s11, 0x3f800000
    s_mov_b32 s26, 0xbf317218
    s_mov_b32 s27, s26
    s_waitcnt vmcnt(14)
    v_mfma_f32_32x32x16_bf16 v[0:15], a[24:27], v[88:91], v[0:15]
    v_mfma_f32_32x32x16_bf16 v[16:31], a[28:31], v[88:91], v[16:31]
    buffer_load_dwordx4 v[88:91], v141, s[64:67], s21 offen offset:2048 sc1
    s_waitcnt vmcnt(14)
    v_mfma_f32_32x32x16_bf16 v[32:47], a[24:27], v[92:95], v[32:47]
    v_mfma_f32_32x32x16_bf16 v[48:63], a[28:31], v[92:95], v[48:63]
    buffer_load_dwordx4 v[92:95], v141, s[64:67], s20 offen offset:3072 sc1
    s_add_u32 s20, s20, 4096
    s_waitcnt vmcnt(14)
    v_mfma_f32_32x32x16_bf16 v[0:15], a[32:35], v[96:99], v[0:15]
    v_mfma_f32_32x32x16_bf16 v[16:31], a[36:39], v[96:99], v[16:31]
    buffer_load_dwordx4 v[96:99], v141, s[64:67], s21 offen offset:3072 sc1
    s_add_u32 s21, s21, 4096
    s_waitcnt vmcnt(14)
    v_mfma_f32_32x32x16_bf16 v[32:47], a[32:35], v[100:103], v[32:47]
    v_mfma_f32_32x32x16_bf16 v[48:63], a[36:39], v[100:103], v[48:63]
    buffer_load_dwordx4 v[100:103], v141, s[64:67], s20 offen offset:0 sc1
    s_waitcnt vmcnt(14)
    v_mfma_f32_32x32x16_bf16 v[0:15], a[40:43], v[104:107], v[0:15]
    v_mfma_f32_32x32x16_bf16 v[16:31], a[44:47], v[104:107], v[16:31]
    buffer_load_dwordx4 v[104:107], v141, s[64:67], s21 offen offset:0 sc1
    s_waitcnt vmcnt(14)
    v_mfma_f32_32x32x16_bf16 v[32:47], a[40:43], v[108:111], v[32:47]
    v_mfma_f32_32x32x16_bf16 v[48:63], a[44:47], v[108:111], v[48:63]
    buffer_load_dwordx4 v[108:111], v141, s[64:67], s20 offen offset:1024 sc1
    s_waitcnt vmcnt(14)
    v_mfma_f32_32x32x16_bf16 v[0:15], a[48:51], v[112:115], v[0:15]
    v_mfma_f32_32x32x16_bf16 v[16:31], a[52:55], v[112:115], v[16:31]
    buffer_load_dwordx4 v[112:115], v141, s[64:67], s21 offen offset:1024 sc1
    buffer_load_dwordx4 v[132:135], v130, s[36:39], s100 offen
    s_waitcnt vmcnt(15)
    v_mfma_f32_32x32x16_bf16 v[32:47], a[48:51], v[116:119], v[32:47]
    v_mfma_f32_32x32x16_bf16 v[48:63], a[52:55], v[116:119], v[48:63]
    s_mul_i32 s23, s4, 50176
    s_lshl_b32 s24, s17, 7
    s_add_u32 s23, s23, s24
    s_mul_i32 s24, s4, 7168
    s_add_u32 m0, s24, 0
    s_add_u32 s8, s23, 0
    buffer_load_dwordx4 v139, s[48:51], s8 offen lds
    buffer_load_dwordx4 v125, s[48:51], s8 offen offset:1024 lds
    s_waitcnt vmcnt(16)
    v_mfma_f32_32x32x16_bf16 v[0:15], a[56:59], v[120:123], v[0:15]
    v_mfma_f32_32x32x16_bf16 v[16:31], a[60:63], v[120:123], v[16:31]
    s_waitcnt vmcnt(15)
    v_mfma_f32_32x32x16_bf16 v[32:47], a[56:59], v[64:67], v[32:47]
    v_mfma_f32_32x32x16_bf16 v[48:63], a[60:63], v[64:67], v[48:63]
    s_add_u32 m0, s24, 2048
    s_add_u32 s8, s23, 14336
    buffer_load_dwordx4 v139, s[48:51], s8 offen lds
    buffer_load_dwordx4 v125, s[48:51], s8 offen offset:1024 lds
    s_waitcnt vmcnt(16)
    v_mfma_f32_32x32x16_bf16 v[0:15], a[64:67], v[68:71], v[0:15]
    v_mfma_f32_32x32x16_bf16 v[16:31], a[68:71], v[68:71], v[16:31]
    s_waitcnt vmcnt(15)
    v_mfma_f32_32x32x16_bf16 v[32:47], a[64:67], v[72:75], v[32:47]
    v_mfma_f32_32x32x16_bf16 v[48:63], a[68:71], v[72:75], v[48:63]
    s_add_u32 m0, s24, 4096
    s_add_u32 s8, s23, 28672
    buffer_load_dwordx4 v139, s[48:51], s8 offen lds
    buffer_load_dwordx4 v125, s[48:51], s8 offen offset:1024 lds
    s_waitcnt vmcnt(16) lgkmcnt(15)
    v_mfma_f32_32x32x16_bf16 v[0:15], a[72:75], v[76:79], v[0:15]
    v_mfma_f32_32x32x16_bf16 v[16:31], a[76:79], v[76:79], v[16:31]
    s_waitcnt vmcnt(15)
    v_mfma_f32_32x32x16_bf16 v[32:47], a[72:75], v[80:83], v[32:47]
    v_mfma_f32_32x32x16_bf16 v[48:63], a[76:79], v[80:83], v[48:63]
    s_add_u32 m0, s24, 6144
    s_add_u32 s8, s23, 43008
    buffer_load_dwordx4 v139, s[48:51], s8 offen lds
    s_waitcnt vmcnt(15) lgkmcnt(14)
    v_mfma_f32_32x32x16_bf16 v[0:15], a[80:83], v[84:87], v[0:15]
    s_waitcnt lgkmcnt(12)
    v_mfma_f32_32x32x16_bf16 v[16:31], a[84:87], v[84:87], v[16:31]
    s_waitcnt vmcnt(14)
    v_mfma_f32_32x32x16_bf16 v[32:47], a[80:83], v[88:91], v[32:47]
    v_mfma_f32_32x32x16_bf16 v[48:63], a[84:87], v[88:91], v[48:63]
    s_waitcnt vmcnt(13) lgkmcnt(10)
    v_mfma_f32_32x32x16_bf16 v[0:15], a[88:91], v[92:95], v[0:15]
    s_waitcnt lgkmcnt(8)
    v_mfma_f32_32x32x16_bf16 v[16:31], a[92:95], v[92:95], v[16:31]
    s_waitcnt vmcnt(12)
    v_mfma_f32_32x32x16_bf16 v[32:47], a[88:91], v[96:99], v[32:47]
    v_mfma_f32_32x32x16_bf16 v[48:63], a[92:95], v[96:99], v[48:63]
    s_waitcnt vmcnt(11) lgkmcnt(6)
    v_mfma_f32_32x32x16_bf16 v[0:15], a[96:99], v[100:103], v[0:15]
    s_waitcnt lgkmcnt(4)
    v_mfma_f32_32x32x16_bf16 v[16:31], a[100:103], v[100:103], v[16:31]
    s_waitcnt vmcnt(10)
    v_mfma_f32_32x32x16_bf16 v[32:47], a[96:99], v[104:107], v[32:47]
    v_mfma_f32_32x32x16_bf16 v[48:63], a[100:103], v[104:107], v[48:63]
    s_waitcnt vmcnt(9) lgkmcnt(2)
    v_mfma_f32_32x32x16_bf16 v[0:15], a[104:107], v[108:111], v[0:15]
    s_waitcnt lgkmcnt(0)
    v_mfma_f32_32x32x16_bf16 v[16:31], a[108:111], v[108:111], v[16:31]
    s_waitcnt vmcnt(8)
    v_mfma_f32_32x32x16_bf16 v[32:47], a[104:107], v[112:115], v[32:47]
    v_mfma_f32_32x32x16_bf16 v[48:63], a[108:111], v[112:115], v[48:63]
    buffer_load_dword v128, v131, s[64:67], s99 offen sc1
    v_xor_b32 v112, 0, v124
    s_nop 4
    v_cvt_pk_bf16_f32 v0, v0, v1
    v_cvt_pk_bf16_f32 v1, v2, v3
    ds_write_b64 v112, v[0:1] offset:0
    s_nop 0
    v_cvt_pk_bf16_f32 v32, v32, v33
    v_cvt_pk_bf16_f32 v33, v34, v35
    ds_write_b64 v112, v[32:33] offset:32768
    v_xor_b32 v113, 16, v124
    v_cvt_pk_bf16_f32 v2, v4, v5
    v_cvt_pk_bf16_f32 v3, v6, v7
    ds_write_b64 v113, v[2:3] offset:0
    v_cvt_pk_bf16_f32 v34, v36, v37
    v_cvt_pk_bf16_f32 v35, v38, v39
    ds_write_b64 v113, v[34:35] offset:32768
    v_xor_b32_e64 v114, 32, v124
    v_cvt_pk_bf16_f32 v4, v8, v9
    v_cvt_pk_bf16_f32 v5, v10, v11
    ds_write_b64 v114, v[4:5] offset:0
    v_cvt_pk_bf16_f32 v36, v40, v41
    v_cvt_pk_bf16_f32 v37, v42, v43
    ds_write_b64 v114, v[36:37] offset:32768
    v_xor_b32_e64 v115, 48, v124
    v_cvt_pk_bf16_f32 v6, v12, v13
    v_cvt_pk_bf16_f32 v7, v14, v15
    ds_write_b64 v115, v[6:7] offset:0
    v_cvt_pk_bf16_f32 v38, v44, v45
    v_cvt_pk_bf16_f32 v39, v46, v47
    ds_write_b64 v115, v[38:39] offset:32768
    v_xor_b32_e64 v116, 64, v124
    v_cvt_pk_bf16_f32 v16, v16, v17
    v_cvt_pk_bf16_f32 v17, v18, v19
    ds_write_b64 v116, v[16:17] offset:0
    v_cvt_pk_bf16_f32 v48, v48, v49
    v_cvt_pk_bf16_f32 v49, v50, v51
    ds_write_b64 v116, v[48:49] offset:32768
    v_xor_b32 v117, 80, v124
    v_cvt_pk_bf16_f32 v18, v20, v21
    v_cvt_pk_bf16_f32 v19, v22, v23
    ds_write_b64 v117, v[18:19] offset:0
    v_cvt_pk_bf16_f32 v50, v52, v53
    v_cvt_pk_bf16_f32 v51, v54, v55
    ds_write_b64 v117, v[50:51] offset:32768
    v_xor_b32 v118, 96, v124
    v_cvt_pk_bf16_f32 v20, v24, v25
    v_cvt_pk_bf16_f32 v21, v26, v27
    ds_write_b64 v118, v[20:21] offset:0
    v_cvt_pk_bf16_f32 v52, v56, v57
    v_cvt_pk_bf16_f32 v53, v58, v59
    ds_write_b64 v118, v[52:53] offset:32768
    v_xor_b32 v119, 112, v124
    v_cvt_pk_bf16_f32 v22, v28, v29
    v_cvt_pk_bf16_f32 v23, v30, v31
    ds_write_b64 v119, v[22:23] offset:0
    v_cvt_pk_bf16_f32 v54, v60, v61
    v_cvt_pk_bf16_f32 v55, v62, v63
    ds_write_b64 v119, v[54:55] offset:32768
    s_waitcnt vmcnt(0)
    v_cmp_ne_u32 vcc, s35, v128
    s_waitcnt lgkmcnt(0)
    s_mov_b64 s[8:9], vcc
    s_barrier
    ds_read_b128 v[8:11], v127 offset:0
    ds_read_b128 v[12:15], v127 offset:4096
    ds_read_b128 v[16:19], v127 offset:8192
    ds_read_b128 v[20:23], v127 offset:12288
    ds_read_b128 v[24:27], v127 offset:16384
    ds_read_b128 v[28:31], v127 offset:20480
    ds_read_b128 v[32:35], v127 offset:24576
    ds_read_b128 v[36:39], v127 offset:28672
    s_cbranch_vccnz L_olate1
    buffer_load_dwordx4 v[64:67], v141, s[64:67], s22 offen offset:0 sc1
    buffer_load_dwordx4 v[68:71], v141, s[64:67], s22 offen offset:1024 sc1
    buffer_load_dwordx4 v[72:75], v141, s[64:67], s22 offen offset:2048 sc1
    buffer_load_dwordx4 v[76:79], v141, s[64:67], s22 offen offset:3072 sc1
    buffer_load_dwordx4 v[80:83], v141, s[64:67], s25 offen offset:0 sc1
    buffer_load_dwordx4 v[84:87], v141, s[64:67], s25 offen offset:1024 sc1
    buffer_load_dwordx4 v[88:91], v141, s[64:67], s25 offen offset:2048 sc1
    buffer_load_dwordx4 v[92:95], v141, s[64:67], s25 offen offset:3072 sc1
    buffer_load_dwordx4 v[96:99], v141, s[64:67], s28 offen offset:0 sc1
    buffer_load_dwordx4 v[100:103], v141, s[64:67], s28 offen offset:1024 sc1
    buffer_load_dwordx4 v[104:107], v141, s[64:67], s28 offen offset:2048 sc1
    buffer_load_dwordx4 v[108:111], v141, s[64:67], s28 offen offset:3072 sc1
    buffer_load_dwordx4 v[112:115], v141, s[64:67], s29 offen offset:0 sc1
    buffer_load_dwordx4 v[116:119], v141, s[64:67], s29 offen offset:1024 sc1
L_olate1:
    v_lshlrev_b32 v40, 16, v132
    v_and_b32 v41, s3, v132
    v_lshlrev_b32 v42, 16, v133
    v_and_b32 v43, s3, v133
    v_lshlrev_b32 v44, 16, v134
    v_and_b32 v45, s3, v134
    v_lshlrev_b32 v46, 16, v135
    v_and_b32_e64 v47, s3, v135
    ds_read_b64_tr_b16 a[0:1], v136 offset:0
    ds_read_b64_tr_b16 a[2:3], v136 offset:512
    ds_read_b64_tr_b16 a[4:5], v136 offset:1024
    ds_read_b64_tr_b16 a[6:7], v138 offset:1536
    s_waitcnt lgkmcnt(11)
    v_dot2_f32_bf16 v0, v8, s10, 0
    v_dot2_f32_bf16 v1, v8, s11, 0
    v_dot2_f32_bf16 v2, v9, s10, 0
    v_dot2_f32_bf16 v3, v9, s11, 0
    v_dot2_f32_bf16 v4, v10, s10, 0
    v_dot2_f32_bf16 v5, v10, s11, 0
    v_dot2_f32_bf16 v6, v11, s10, 0
    v_dot2_f32_bf16 v7, v11, s11, 0
    ds_read_b64_tr_b16 a[8:9], v137 offset:3840
    ds_read_b64_tr_b16 a[10:11], v137 offset:4352
    ds_read_b64_tr_b16 a[12:13], v137 offset:4864
    ds_read_b64_tr_b16 a[14:15], v136 offset:7168
    s_waitcnt lgkmcnt(14)
    v_dot2_f32_bf16 v0, v12, s10, v0
    v_dot2_f32_bf16 v1, v12, s11, v1
    v_dot2_f32_bf16 v2, v13, s10, v2
    v_dot2_f32_bf16 v3, v13, s11, v3
    v_dot2_f32_bf16 v4, v14, s10, v4
    v_dot2_f32_bf16 v5, v14, s11, v5
    v_dot2_f32_bf16 v6, v15, s10, v6
    v_dot2_f32_bf16 v7, v15, s11, v7
    ds_read_b64_tr_b16 a[16:17], v136 offset:7680
    ds_read_b64_tr_b16 a[18:19], v136 offset:8192
    ds_read_b64_tr_b16 a[20:21], v138 offset:8704
    ds_read_b64_tr_b16 a[22:23], v137 offset:11008
    s_waitcnt lgkmcnt(15)
    v_dot2_f32_bf16 v0, v16, s10, v0
    v_dot2_f32_bf16 v1, v16, s11, v1
    v_dot2_f32_bf16 v2, v17, s10, v2
    v_dot2_f32_bf16 v3, v17, s11, v3
    v_dot2_f32_bf16 v4, v18, s10, v4
    v_dot2_f32_bf16 v5, v18, s11, v5
    v_dot2_f32_bf16 v6, v19, s10, v6
    v_dot2_f32_bf16 v7, v19, s11, v7
    ds_read_b64_tr_b16 a[24:25], v137 offset:11520
    ds_read_b64_tr_b16 a[26:27], v137 offset:12032
    ds_read_b64_tr_b16 a[28:29], v136 offset:14336
    ds_read_b64_tr_b16 a[30:31], v136 offset:14848
    v_dot2_f32_bf16 v0, v20, s10, v0
    v_dot2_f32_bf16 v1, v20, s11, v1
    v_dot2_f32_bf16 v2, v21, s10, v2
    v_dot2_f32_bf16 v3, v21, s11, v3
    v_dot2_f32_bf16 v4, v22, s10, v4
    v_dot2_f32_bf16 v5, v22, s11, v5
    v_dot2_f32_bf16 v6, v23, s10, v6
    v_dot2_f32_bf16 v7, v23, s11, v7
    ds_read_b64_tr_b16 a[32:33], v136 offset:15360
    ds_read_b64_tr_b16 a[34:35], v138 offset:15872
    ds_read_b64_tr_b16 a[36:37], v137 offset:18176
    ds_read_b64_tr_b16 a[38:39], v137 offset:18688
    v_dot2_f32_bf16 v0, v24, s10, v0
    v_dot2_f32_bf16 v1, v24, s11, v1
    v_dot2_f32_bf16 v2, v25, s10, v2
    v_dot2_f32_bf16 v3, v25, s11, v3
    v_dot2_f32_bf16 v4, v26, s10, v4
    v_dot2_f32_bf16 v5, v26, s11, v5
    v_dot2_f32_bf16 v6, v27, s10, v6
    v_dot2_f32_bf16 v7, v27, s11, v7
    ds_read_b64_tr_b16 a[40:41], v137 offset:19200
    ds_read_b64_tr_b16 a[42:43], v136 offset:21504
    ds_read_b64_tr_b16 a[44:45], v136 offset:22016
    ds_read_b64_tr_b16 a[46:47], v136 offset:22528
    s_waitcnt lgkmcnt(15)
    s_nop 0
    v_dot2_f32_bf16 v0, v28, s10, v0
    v_dot2_f32_bf16 v1, v28, s11, v1
    v_dot2_f32_bf16 v2, v29, s10, v2
    v_dot2_f32_bf16 v3, v29, s11, v3
    v_dot2_f32_bf16 v4, v30, s10, v4
    v_dot2_f32_bf16 v5, v30, s11, v5
    v_dot2_f32_bf16 v6, v31, s10, v6
    v_dot2_f32_bf16 v7, v31, s11, v7
    ds_read_b64_tr_b16 a[48:49], v138 offset:23040
    ds_read_b64_tr_b16 a[50:51], v137 offset:25344
    ds_read_b64_tr_b16 a[52:53], v137 offset:25856
    ds_read_b64_tr_b16 a[54:55], v137 offset:26368
    v_dot2_f32_bf16 v0, v32, s10, v0
    v_dot2_f32_bf16 v1, v32, s11, v1
    v_dot2_f32_bf16 v2, v33, s10, v2
    v_dot2_f32_bf16 v3, v33, s11, v3
    v_dot2_f32_bf16 v4, v34, s10, v4
    v_dot2_f32_bf16 v5, v34, s11, v5
    v_dot2_f32_bf16 v6, v35, s10, v6
    v_dot2_f32_bf16 v7, v35, s11, v7
    v_dot2_f32_bf16 v0, v36, s10, v0
    v_dot2_f32_bf16 v1, v36, s11, v1
    v_dot2_f32_bf16 v2, v37, s10, v2
    v_dot2_f32_bf16 v3, v37, s11, v3
    v_dot2_f32_bf16 v4, v38, s10, v4
    v_dot2_f32_bf16 v5, v38, s11, v5
    v_dot2_f32_bf16 v6, v39, s10, v6
    v_dot2_f32_bf16 v7, v39, s11, v7
    s_cmp_eq_u64 s[8:9], 0
    s_cbranch_scc1 L_oearly
L_pollO:
    buffer_load_dword v128, v131, s[64:67], s99 offen sc1
    s_waitcnt vmcnt(0)
    v_cmp_ne_u32 vcc, s35, v128
    s_nop 1
    s_cbranch_vccz L_polldO
    s_nop 0
    s_add_u32 s31, s31, 1
    s_cmp_lt_u32 s31, 0x8000
    s_cbranch_scc1 L_pollO
L_polldO:
    buffer_load_dwordx4 v[64:67], v141, s[64:67], s22 offen offset:0 sc1
    buffer_load_dwordx4 v[68:71], v141, s[64:67], s22 offen offset:1024 sc1
    buffer_load_dwordx4 v[72:75], v141, s[64:67], s22 offen offset:2048 sc1
    buffer_load_dwordx4 v[76:79], v141, s[64:67], s22 offen offset:3072 sc1
    buffer_load_dwordx4 v[80:83], v141, s[64:67], s25 offen offset:0 sc1
    buffer_load_dwordx4 v[84:87], v141, s[64:67], s25 offen offset:1024 sc1
    buffer_load_dwordx4 v[88:91], v141, s[64:67], s25 offen offset:2048 sc1
    buffer_load_dwordx4 v[92:95], v141, s[64:67], s25 offen offset:3072 sc1
    buffer_load_dwordx4 v[96:99], v141, s[64:67], s28 offen offset:0 sc1
    buffer_load_dwordx4 v[100:103], v141, s[64:67], s28 offen offset:1024 sc1
    buffer_load_dwordx4 v[104:107], v141, s[64:67], s28 offen offset:2048 sc1
    buffer_load_dwordx4 v[108:111], v141, s[64:67], s28 offen offset:3072 sc1
    buffer_load_dwordx4 v[112:115], v141, s[64:67], s29 offen offset:0 sc1
    buffer_load_dwordx4 v[116:119], v141, s[64:67], s29 offen offset:1024 sc1
L_oearly:
    v_exp_f32 v8, v0
    v_exp_f32 v9, v1
    v_exp_f32 v10, v2
    v_exp_f32 v11, v3
    v_exp_f32 v12, v4
    v_exp_f32 v13, v5
    v_exp_f32 v14, v6
    v_exp_f32 v15, v7
    v_xor_b32 v120, 0, v142
    v_xor_b32 v121, 16, v142
    v_xor_b32 v122, 32, v142
    v_xor_b32_e64 v123, 48, v142
    v_pk_add_f32 v[8:9], v[8:9], 1.0 op_sel_hi:[1,0]
    v_pk_add_f32 v[10:11], v[10:11], 1.0 op_sel_hi:[1,0]
    v_pk_add_f32 v[12:13], v[12:13], 1.0 op_sel_hi:[1,0]
    v_pk_add_f32 v[14:15], v[14:15], 1.0 op_sel_hi:[1,0]
    v_rcp_f32 v8, v8
    v_rcp_f32 v9, v9
    v_rcp_f32 v10, v10
    v_rcp_f32 v11, v11
    v_rcp_f32 v12, v12
    v_rcp_f32 v13, v13
    v_rcp_f32 v14, v14
    v_rcp_f32 v15, v15
    v_pk_mul_f32 v[0:1], v[0:1], s[26:27]
    v_pk_mul_f32 v[2:3], v[2:3], s[26:27]
    v_pk_mul_f32 v[4:5], v[4:5], s[26:27]
    v_pk_mul_f32 v[6:7], v[6:7], s[26:27]
    v_pk_mul_f32 v[0:1], v[0:1], v[8:9]
    v_pk_mul_f32 v[2:3], v[2:3], v[10:11]
    v_pk_mul_f32 v[4:5], v[4:5], v[12:13]
    v_pk_mul_f32 v[6:7], v[6:7], v[14:15]
    s_waitcnt vmcnt(12)
    v_mfma_f32_32x32x16_bf16 v[48:63], a[0:3], v[64:67], 0
    v_mfma_f32_32x32x16_bf16 v[48:63], a[4:7], v[68:71], v[48:63]
    s_waitcnt vmcnt(10)
    v_mfma_f32_32x32x16_bf16 v[48:63], a[8:11], v[72:75], v[48:63]
    v_mfma_f32_32x32x16_bf16 v[48:63], a[12:15], v[76:79], v[48:63]
    s_waitcnt vmcnt(8)
    s_waitcnt lgkmcnt(15)
    v_mfma_f32_32x32x16_bf16 v[48:63], a[16:19], v[80:83], v[48:63]
    v_mfma_f32_32x32x16_bf16 v[48:63], a[20:23], v[84:87], v[48:63]
    s_waitcnt vmcnt(6)
    s_waitcnt lgkmcnt(14)
    v_mfma_f32_32x32x16_bf16 v[48:63], a[24:27], v[88:91], v[48:63]
    s_waitcnt lgkmcnt(12)
    v_mfma_f32_32x32x16_bf16 v[48:63], a[28:31], v[92:95], v[48:63]
    s_waitcnt vmcnt(4)
    s_waitcnt lgkmcnt(10)
    v_mfma_f32_32x32x16_bf16 v[48:63], a[32:35], v[96:99], v[48:63]
    s_waitcnt lgkmcnt(8)
    v_mfma_f32_32x32x16_bf16 v[48:63], a[36:39], v[100:103], v[48:63]
    s_waitcnt vmcnt(2)
    s_waitcnt lgkmcnt(6)
    v_mfma_f32_32x32x16_bf16 v[48:63], a[40:43], v[104:107], v[48:63]
    s_waitcnt lgkmcnt(4)
    v_mfma_f32_32x32x16_bf16 v[48:63], a[44:47], v[108:111], v[48:63]
    s_waitcnt vmcnt(0)
    s_waitcnt lgkmcnt(2)
    v_mfma_f32_32x32x16_bf16 v[48:63], a[48:51], v[112:115], v[48:63]
    s_waitcnt lgkmcnt(0)
    v_mfma_f32_32x32x16_bf16 v[48:63], a[52:55], v[116:119], v[48:63]
    s_nop 11
    v_cvt_pk_bf16_f32 v48, v48, v49
    v_cvt_pk_bf16_f32 v49, v50, v51
    ds_write_b64 v120, v[48:49]
    v_cvt_pk_bf16_f32 v50, v52, v53
    v_cvt_pk_bf16_f32 v51, v54, v55
    ds_write_b64 v121, v[50:51]
    v_cvt_pk_bf16_f32 v52, v56, v57
    v_cvt_pk_bf16_f32 v53, v58, v59
    ds_write_b64 v122, v[52:53]
    v_cvt_pk_bf16_f32 v54, v60, v61
    v_cvt_pk_bf16_f32 v55, v62, v63
    ds_write_b64 v123, v[54:55]
    s_waitcnt lgkmcnt(0)
    s_barrier
    ds_read_b128 v[16:19], v143 offset:0
    ds_read_b128 v[20:23], v143 offset:8192
    s_waitcnt lgkmcnt(1)
    v_dot2_f32_bf16 v24, v16, s10, 0
    v_dot2_f32_bf16 v25, v16, s11, 0
    v_dot2_f32_bf16 v26, v17, s10, 0
    v_dot2_f32_bf16 v27, v17, s11, 0
    v_dot2_f32_bf16 v28, v18, s10, 0
    v_dot2_f32_bf16 v29, v18, s11, 0
    v_dot2_f32_bf16 v30, v19, s10, 0
    v_dot2_f32_bf16 v31, v19, s11, 0
    s_waitcnt lgkmcnt(0)
    s_nop 0
    v_dot2_f32_bf16 v24, v20, s10, v24
    v_dot2_f32_bf16 v25, v20, s11, v25
    v_dot2_f32_bf16 v26, v21, s10, v26
    v_dot2_f32_bf16 v27, v21, s11, v27
    v_dot2_f32_bf16 v28, v22, s10, v28
    v_dot2_f32_bf16 v29, v22, s11, v29
    v_dot2_f32_bf16 v30, v23, s10, v30
    v_dot2_f32_bf16 v31, v23, s11, v31
    v_pk_fma_f32 v[0:1], v[0:1], v[24:25], v[40:41]
    v_pk_fma_f32 v[2:3], v[2:3], v[26:27], v[42:43]
    v_pk_fma_f32 v[4:5], v[4:5], v[28:29], v[44:45]
    v_pk_fma_f32 v[6:7], v[6:7], v[30:31], v[46:47]
    v_cvt_pk_bf16_f32 v8, v0, v1
    v_cvt_pk_bf16_f32 v9, v2, v3
    v_cvt_pk_bf16_f32 v10, v4, v5
    v_cvt_pk_bf16_f32 v11, v6, v7
    buffer_store_dwordx4 v[8:11], v130, s[56:59], s100 offen
    s_endpgm
    s_nop 0
L_end:
    s_endpgm
.section .rodata,"a"
.p2align 6
.amdhsa_kernel recurrent_scan__linear_kernel_hedgehog__dense_activation_silu__prompt_kernel
  .amdhsa_next_free_vgpr 256
  .amdhsa_next_free_sgpr 102
  .amdhsa_accum_offset 144
  .amdhsa_group_segment_fixed_size 0
  .amdhsa_kernarg_size 80
  .amdhsa_user_sgpr_count 2
  .amdhsa_user_sgpr_kernarg_segment_ptr 1
  .amdhsa_system_sgpr_workgroup_id_x 1
.end_amdhsa_kernel
```
